```python
import torch

def _softmax(x, axis=-1):
    return torch.softmax(x, dim=axis)
def _gelu(x):
    return torch.nn.functional.gelu(x, approximate="tanh")
def _silu(x):
    return torch.nn.functional.silu(x)
def _sigmoid(x):
    return torch.sigmoid(x)
def _layernorm(x, axis=-1, eps=1e-5):
    m = x.mean(dim=axis, keepdim=True)
    v = x.var(dim=axis, keepdim=True, unbiased=False)
    return (x - m) / torch.sqrt(v + eps)
def _scatter_add(tgt, idx, src, axis=0):
    return tgt.clone().index_add_(axis, idx, src)
def _segment_sum(src, seg, n):
    out = torch.zeros((n,) + src.shape[1:], dtype=src.dtype)
    return out.index_add_(0, seg, src)
def _pad(x, pw):
    flat = tuple(v for pair in reversed(pw) for v in pair)
    return torch.nn.functional.pad(x, flat)

kernel_name = 'standalone__dense_activation_squared_relu__sampling'

def setup_inputs():

    _w = (lambda a: (lambda t: t.to(torch.bfloat16) if t.is_floating_point() else t)(torch.as_tensor(a)))
    B, S, D, F = 32, 16, 576, 4608
    return {
        "x": _w((lambda *s: torch.randn(*s, dtype=torch.bfloat16) * 0.05)(B, S, D)),
        "w1": _w((lambda *s: torch.randn(*s, dtype=torch.bfloat16) * 0.05)(D, F)),
        "b1": _w((lambda *s: torch.randn(*s, dtype=torch.bfloat16) * 0.05)(F)),
        "w2": _w((lambda *s: torch.randn(*s, dtype=torch.bfloat16) * 0.05)(F, D)),
        "b2": _w((lambda *s: torch.randn(*s, dtype=torch.bfloat16) * 0.05)(D)),
    }

def reference(x, w1, b1, w2, b2):
    h = torch.einsum("bsd,df->bsf", x, w1) + b1
    zero = torch.zeros_like(h)
    r = torch.where(h > zero, h, zero)
    h = r * r
    out = torch.einsum("bsf,fd->bsd", h, w2) + b2
    return out
```

```asm
; @launch grid=(256,1,1) block=(512,1,1) lds=163840
.amdgcn_target "amdgcn-amd-amdhsa--gfx950"
.text
.globl standalone__dense_activation_squared_relu__sampling_kernel
.p2align 8
.type standalone__dense_activation_squared_relu__sampling_kernel,@function
standalone__dense_activation_squared_relu__sampling_kernel:
    s_cmp_ge_u32 s2, 256
    s_cbranch_scc1 L_end
    s_load_dwordx16 s[16:31], s[0:1], 0
    s_getpc_b64 s[4:5]
L_pc:
    s_lshr_b32 s3, s2, 3
    s_lshl_b32 s3, s3, 11
    v_lshrrev_b32 v2, 5, v0
    v_lshl_add_u32 v2, v2, 7, s3
    v_min_u32 v2, L_end-L_pc, v2
    v_and_b32 v2, 0xfffffffc, v2
    global_load_dword v255, v2, s[4:5]
    v_and_b32 v1, 63, v0
    v_lshrrev_b32 v2, 6, v0
    s_and_b32 s32, s2, 7
    v_readfirstlane_b32 s36, v2
    s_lshr_b32 s33, s2, 3
    s_cmp_lt_u32 s33, 8
    s_cbranch_scc1 L_helper
    s_sub_u32 s33, s33, 8
    s_mul_i32 s34, s33, 21846
    s_lshr_b32 s34, s34, 16
    s_mul_i32 s52, s34, 3
    s_sub_u32 s35, s33, s52
    s_mul_i32 s37, s32, 24
    s_add_u32 s37, s37, s33
    s_cmp_lt_u32 s36, 4
    s_cbranch_scc1 L_compute
    s_cmp_eq_u32 s36, 6
    s_cbranch_scc1 L_xh
    s_cmp_eq_u32 s36, 7
    s_cbranch_scc1 L_h2
    s_sub_u32 s57, s36, 4
    v_lshrrev_b32 v2, 3, v1
    v_and_b32 v3, 7, v1
    v_bfe_u32 v4, v1, 4, 1
    v_lshlrev_b32 v4, 2, v4
    v_xor_b32 v3, v3, v4
    v_lshrrev_b32 v4, 5, v1
    v_lshlrev_b32 v4, 1, v4
    v_xor_b32 v3, v3, v4
    v_lshlrev_b32 v3, 4, v3
    v_lshrrev_b32 v4, 2, v2
    v_and_b32 v5, 3, v2
    v_lshl_add_u32 v4, v4, 3, v5
    s_lshl_b32 s52, s57, 5
    v_add_u32 v4, s52, v4
    v_mul_u32_u24 v4, 9216, v4
    v_add_u32 v4, v4, v3
    v_add_u32 v5, 35840, v4
    v_add_u32 v6, 145408, v4
    v_add_u32 v7, 181248, v4
    s_lshl_b32 s56, s57, 12
    s_mul_i32 s38, s32, 1152
    s_mul_i32 s53, s35, 384
    s_add_u32 s38, s38, s53
    s_waitcnt lgkmcnt(0)
    s_mov_b32 s40, s18
    s_mov_b32 s41, s19
    s_mov_b32 s42, 5308416
    s_mov_b32 s43, 0x00020000
    s_add_u32 m0, s56, 0
    s_add_u32 s52, s38, 0
    buffer_load_dwordx4 v4, s[40:43], s52 offen offset:0  lds
    buffer_load_dwordx4 v5, s[40:43], s52 offen offset:1024  lds
    buffer_load_dwordx4 v6, s[40:43], s52 offen offset:2048  lds
    buffer_load_dwordx4 v7, s[40:43], s52 offen offset:3072  lds
    s_add_u32 m0, s56, 8192
    s_add_u32 s52, s38, 128
    buffer_load_dwordx4 v4, s[40:43], s52 offen offset:0  lds
    buffer_load_dwordx4 v5, s[40:43], s52 offen offset:1024  lds
    buffer_load_dwordx4 v6, s[40:43], s52 offen offset:2048  lds
    buffer_load_dwordx4 v7, s[40:43], s52 offen offset:3072  lds
    s_add_u32 m0, s56, 16384
    s_add_u32 s52, s38, 256
    buffer_load_dwordx4 v4, s[40:43], s52 offen offset:0  lds
    buffer_load_dwordx4 v5, s[40:43], s52 offen offset:1024  lds
    buffer_load_dwordx4 v6, s[40:43], s52 offen offset:2048  lds
    buffer_load_dwordx4 v7, s[40:43], s52 offen offset:3072  lds
    s_branch L_tail_w
L_xh:
    v_lshrrev_b32 v2, 3, v1
    v_and_b32 v3, 7, v1
    v_lshrrev_b32 v4, 4, v1
    v_xor_b32 v3, v3, v4
    v_lshlrev_b32 v3, 4, v3
    v_mul_u32_u24 v4, 1152, v2
    v_add_u32 v8, v4, v3
    v_xor_b32 v5, 64, v8
    v_add_u32 v9, 8192, v5
    v_add_u32 v10, 16384, v8
    v_add_u32 v11, 24576, v5
    s_mul_i32 s38, s34, 73728
    s_waitcnt lgkmcnt(0)
    s_mov_b32 s40, s16
    s_mov_b32 s41, s17
    s_mov_b32 s42, 589824
    s_mov_b32 s43, 0x00020000
    s_mov_b32 m0, 131072
    s_add_u32 s52, s38, 0
    buffer_load_dwordx4 v8, s[40:43], s52 offen offset:0 lds
    buffer_load_dwordx4 v9, s[40:43], s52 offen offset:1024 lds
    buffer_load_dwordx4 v10, s[40:43], s52 offen offset:2048 lds
    buffer_load_dwordx4 v11, s[40:43], s52 offen offset:3072 lds
    s_mov_b32 m0, 135168
    s_add_u32 s52, s38, 36864
    buffer_load_dwordx4 v8, s[40:43], s52 offen offset:0 lds
    buffer_load_dwordx4 v9, s[40:43], s52 offen offset:1024 lds
    buffer_load_dwordx4 v10, s[40:43], s52 offen offset:2048 lds
    buffer_load_dwordx4 v11, s[40:43], s52 offen offset:3072 lds
    s_branch L_tail_x
L_h2:
    s_mul_i32 s52, s32, 1152
    s_mul_i32 s53, s35, 384
    s_add_u32 s52, s52, s53
    v_min_u32 v2, 47, v1
    v_lshlrev_b32 v3, 3, v2
    s_waitcnt lgkmcnt(0)
    s_mov_b32 s40, s20
    s_mov_b32 s41, s21
    s_mov_b32 s42, 9216
    s_mov_b32 s43, 0x00020000
    buffer_load_dwordx2 v[4:5], v3, s[40:43], s52 offen
    s_waitcnt lgkmcnt(0)
    s_mov_b32 s44, s30
    s_mov_b32 s45, s31
    s_mov_b32 s46, 268435456
    s_mov_b32 s47, 0x00020000
    s_branch L_tail_h2
L_helper:
    s_lshl_b32 s38, s36, 3
    s_add_u32 s38, s38, s33
    v_mul_u32_u24 v8, 9216, v1
    v_mul_u32_u24 v9, 1152, v1
    s_mul_i32 s39, s32, 1152
    s_cmp_lg_u32 s38, 63
    s_cbranch_scc1 L_nb2
    v_lshlrev_b32 v2, 5, v1
    s_waitcnt lgkmcnt(0)
    s_mov_b32 s48, s24
    s_mov_b32 s49, s25
    s_mov_b32 s50, 1152
    s_mov_b32 s51, 0x00020000
    buffer_load_dword v255, v2, s[48:51], 0 offen
L_nb2:
    s_cmp_ge_u32 s36, 2
    s_cbranch_scc1 L_end
    s_waitcnt lgkmcnt(0)
    s_mov_b32 s40, s18
    s_mov_b32 s41, s19
    s_mov_b32 s42, 5308416
    s_mov_b32 s43, 0x00020000
    s_mov_b32 s44, s16
    s_mov_b32 s45, s17
    s_mov_b32 s46, 589824
    s_mov_b32 s47, 0x00020000
    s_add_u32 s52, s38, 0
    s_cmp_ge_u32 s52, 136
    s_cbranch_scc1 L_hp13
    s_mul_i32 s53, s52, 3856
    s_lshr_b32 s53, s53, 16
    s_mul_i32 s54, s53, 17
    s_sub_u32 s54, s52, s54
    s_add_u32 s53, s53, 1
    s_cmp_ge_u32 s54, 9
    s_cbranch_scc1 L_hx13
    s_mul_i32 s53, s53, 589824
    s_add_u32 s53, s53, s39
    s_lshl_b32 s54, s54, 7
    s_add_u32 s53, s53, s54
    buffer_load_dword v255, v8, s[40:43], s53 offen
    s_branch L_ht12
L_hx13:
    s_sub_u32 s54, s54, 9
    s_mul_i32 s54, s54, 73728
    s_lshl_b32 s53, s53, 7
    s_add_u32 s53, s53, s54
    buffer_load_dword v255, v9, s[44:47], s53 offen
    s_branch L_ht12
L_hp13:
L_ht12:
    s_branch L_tail_hl
L_compute:
    s_and_b32 s56, s36, 1
    s_lshr_b32 s57, s36, 1
    v_lshrrev_b32 v240, 5, v1
    s_waitcnt lgkmcnt(0)
    s_lshl_b32 s52, s34, 7
    s_add_u32 s52, s52, 163577856
    s_load_dword s6, s[30:31], s52
    s_branch L_tail_c
L_heads_end:
L_tail_hl:
    s_add_u32 s52, s38, 16
    s_cmp_ge_u32 s52, 136
    s_cbranch_scc1 L_hp15
    s_mul_i32 s53, s52, 3856
    s_lshr_b32 s53, s53, 16
    s_mul_i32 s54, s53, 17
    s_sub_u32 s54, s52, s54
    s_add_u32 s53, s53, 1
    s_cmp_ge_u32 s54, 9
    s_cbranch_scc1 L_hx15
    s_mul_i32 s53, s53, 589824
    s_add_u32 s53, s53, s39
    s_lshl_b32 s54, s54, 7
    s_add_u32 s53, s53, s54
    buffer_load_dword v255, v8, s[40:43], s53 offen
    s_branch L_ht14
L_hx15:
    s_sub_u32 s54, s54, 9
    s_mul_i32 s54, s54, 73728
    s_lshl_b32 s53, s53, 7
    s_add_u32 s53, s53, s54
    buffer_load_dword v255, v9, s[44:47], s53 offen
    s_branch L_ht14
L_hp15:
L_ht14:
    s_add_u32 s52, s38, 32
    s_cmp_ge_u32 s52, 136
    s_cbranch_scc1 L_hp17
    s_mul_i32 s53, s52, 3856
    s_lshr_b32 s53, s53, 16
    s_mul_i32 s54, s53, 17
    s_sub_u32 s54, s52, s54
    s_add_u32 s53, s53, 1
    s_cmp_ge_u32 s54, 9
    s_cbranch_scc1 L_hx17
    s_mul_i32 s53, s53, 589824
    s_add_u32 s53, s53, s39
    s_lshl_b32 s54, s54, 7
    s_add_u32 s53, s53, s54
    buffer_load_dword v255, v8, s[40:43], s53 offen
    s_branch L_ht16
L_hx17:
    s_sub_u32 s54, s54, 9
    s_mul_i32 s54, s54, 73728
    s_lshl_b32 s53, s53, 7
    s_add_u32 s53, s53, s54
    buffer_load_dword v255, v9, s[44:47], s53 offen
    s_branch L_ht16
L_hp17:
L_ht16:
    s_add_u32 s52, s38, 48
    s_cmp_ge_u32 s52, 136
    s_cbranch_scc1 L_hp19
    s_mul_i32 s53, s52, 3856
    s_lshr_b32 s53, s53, 16
    s_mul_i32 s54, s53, 17
    s_sub_u32 s54, s52, s54
    s_add_u32 s53, s53, 1
    s_cmp_ge_u32 s54, 9
    s_cbranch_scc1 L_hx19
    s_mul_i32 s53, s53, 589824
    s_add_u32 s53, s53, s39
    s_lshl_b32 s54, s54, 7
    s_add_u32 s53, s53, s54
    buffer_load_dword v255, v8, s[40:43], s53 offen
    s_branch L_ht18
L_hx19:
    s_sub_u32 s54, s54, 9
    s_mul_i32 s54, s54, 73728
    s_lshl_b32 s53, s53, 7
    s_add_u32 s53, s53, s54
    buffer_load_dword v255, v9, s[44:47], s53 offen
    s_branch L_ht18
L_hp19:
L_ht18:
    s_add_u32 s52, s38, 64
    s_cmp_ge_u32 s52, 136
    s_cbranch_scc1 L_hp21
    s_mul_i32 s53, s52, 3856
    s_lshr_b32 s53, s53, 16
    s_mul_i32 s54, s53, 17
    s_sub_u32 s54, s52, s54
    s_add_u32 s53, s53, 1
    s_cmp_ge_u32 s54, 9
    s_cbranch_scc1 L_hx21
    s_mul_i32 s53, s53, 589824
    s_add_u32 s53, s53, s39
    s_lshl_b32 s54, s54, 7
    s_add_u32 s53, s53, s54
    buffer_load_dword v255, v8, s[40:43], s53 offen
    s_branch L_ht20
L_hx21:
    s_sub_u32 s54, s54, 9
    s_mul_i32 s54, s54, 73728
    s_lshl_b32 s53, s53, 7
    s_add_u32 s53, s53, s54
    buffer_load_dword v255, v9, s[44:47], s53 offen
    s_branch L_ht20
L_hp21:
L_ht20:
    s_add_u32 s52, s38, 80
    s_cmp_ge_u32 s52, 136
    s_cbranch_scc1 L_hp23
    s_mul_i32 s53, s52, 3856
    s_lshr_b32 s53, s53, 16
    s_mul_i32 s54, s53, 17
    s_sub_u32 s54, s52, s54
    s_add_u32 s53, s53, 1
    s_cmp_ge_u32 s54, 9
    s_cbranch_scc1 L_hx23
    s_mul_i32 s53, s53, 589824
    s_add_u32 s53, s53, s39
    s_lshl_b32 s54, s54, 7
    s_add_u32 s53, s53, s54
    buffer_load_dword v255, v8, s[40:43], s53 offen
    s_branch L_ht22
L_hx23:
    s_sub_u32 s54, s54, 9
    s_mul_i32 s54, s54, 73728
    s_lshl_b32 s53, s53, 7
    s_add_u32 s53, s53, s54
    buffer_load_dword v255, v9, s[44:47], s53 offen
    s_branch L_ht22
L_hp23:
L_ht22:
    s_add_u32 s52, s38, 96
    s_cmp_ge_u32 s52, 136
    s_cbranch_scc1 L_hp25
    s_mul_i32 s53, s52, 3856
    s_lshr_b32 s53, s53, 16
    s_mul_i32 s54, s53, 17
    s_sub_u32 s54, s52, s54
    s_add_u32 s53, s53, 1
    s_cmp_ge_u32 s54, 9
    s_cbranch_scc1 L_hx25
    s_mul_i32 s53, s53, 589824
    s_add_u32 s53, s53, s39
    s_lshl_b32 s54, s54, 7
    s_add_u32 s53, s53, s54
    buffer_load_dword v255, v8, s[40:43], s53 offen
    s_branch L_ht24
L_hx25:
    s_sub_u32 s54, s54, 9
    s_mul_i32 s54, s54, 73728
    s_lshl_b32 s53, s53, 7
    s_add_u32 s53, s53, s54
    buffer_load_dword v255, v9, s[44:47], s53 offen
    s_branch L_ht24
L_hp25:
L_ht24:
    s_add_u32 s52, s38, 112
    s_cmp_ge_u32 s52, 136
    s_cbranch_scc1 L_hp27
    s_mul_i32 s53, s52, 3856
    s_lshr_b32 s53, s53, 16
    s_mul_i32 s54, s53, 17
    s_sub_u32 s54, s52, s54
    s_add_u32 s53, s53, 1
    s_cmp_ge_u32 s54, 9
    s_cbranch_scc1 L_hx27
    s_mul_i32 s53, s53, 589824
    s_add_u32 s53, s53, s39
    s_lshl_b32 s54, s54, 7
    s_add_u32 s53, s53, s54
    buffer_load_dword v255, v8, s[40:43], s53 offen
    s_branch L_ht26
L_hx27:
    s_sub_u32 s54, s54, 9
    s_mul_i32 s54, s54, 73728
    s_lshl_b32 s53, s53, 7
    s_add_u32 s53, s53, s54
    buffer_load_dword v255, v9, s[44:47], s53 offen
    s_branch L_ht26
L_hp27:
L_ht26:
    s_add_u32 s52, s38, 128
    s_cmp_ge_u32 s52, 136
    s_cbranch_scc1 L_hp29
    s_mul_i32 s53, s52, 3856
    s_lshr_b32 s53, s53, 16
    s_mul_i32 s54, s53, 17
    s_sub_u32 s54, s52, s54
    s_add_u32 s53, s53, 1
    s_cmp_ge_u32 s54, 9
    s_cbranch_scc1 L_hx29
    s_mul_i32 s53, s53, 589824
    s_add_u32 s53, s53, s39
    s_lshl_b32 s54, s54, 7
    s_add_u32 s53, s53, s54
    buffer_load_dword v255, v8, s[40:43], s53 offen
    s_branch L_ht28
L_hx29:
    s_sub_u32 s54, s54, 9
    s_mul_i32 s54, s54, 73728
    s_lshl_b32 s53, s53, 7
    s_add_u32 s53, s53, s54
    buffer_load_dword v255, v9, s[44:47], s53 offen
    s_branch L_ht28
L_hp29:
L_ht28:
    s_mov_b32 s40, s22
    s_mov_b32 s41, s23
    s_mov_b32 s42, 5308416
    s_mov_b32 s43, 0x00020000
    s_mul_i32 s39, s32, 663552
    s_mov_b32 s60, 2526281728
    s_mov_b32 s61, 2516582
    s_mov_b32 s62, 1409459520
    s_mov_b32 s63, 2704041
    s_mov_b32 s44, 286411044
    s_mov_b32 s45, 2795841
    s_add_u32 s38, s38, 8
    s_cmp_ge_u32 s38, 16
    s_cselect_b32 s52, 16, 0
    s_sub_u32 s38, s38, s52
    s_add_u32 s52, s38, 0
    s_cmp_ge_u32 s52, 81
    s_cbranch_scc1 L_ht30
    s_mul_i32 s53, s52, 21846
    s_lshr_b32 s53, s53, 16
    s_mul_i32 s54, s53, 3
    s_sub_u32 s54, s52, s54
    s_lshl_b32 s53, s53, 1
    s_lshr_b64 s[46:47], s[60:61], s53
    s_and_b32 s52, s46, 3
    s_add_u32 s52, s52, s54
    s_cmp_ge_u32 s52, 3
    s_cselect_b32 s55, 3, 0
    s_sub_u32 s52, s52, s55
    s_lshr_b64 s[46:47], s[62:63], s53
    s_and_b32 s55, s46, 3
    s_mul_i32 s52, s52, 221184
    s_mul_i32 s55, s55, 73728
    s_add_u32 s52, s52, s55
    s_lshr_b64 s[46:47], s[44:45], s53
    s_and_b32 s55, s46, 3
    s_mul_i32 s54, s54, 3
    s_add_u32 s54, s54, s55
    s_lshl_b32 s54, s54, 7
    s_add_u32 s52, s52, s54
    s_add_u32 s52, s52, s39
    buffer_load_dword v255, v9, s[40:43], s52 offen
L_ht30:
    s_add_u32 s52, s38, 16
    s_cmp_ge_u32 s52, 81
    s_cbranch_scc1 L_ht31
    s_mul_i32 s53, s52, 21846
    s_lshr_b32 s53, s53, 16
    s_mul_i32 s54, s53, 3
    s_sub_u32 s54, s52, s54
    s_lshl_b32 s53, s53, 1
    s_lshr_b64 s[46:47], s[60:61], s53
    s_and_b32 s52, s46, 3
    s_add_u32 s52, s52, s54
    s_cmp_ge_u32 s52, 3
    s_cselect_b32 s55, 3, 0
    s_sub_u32 s52, s52, s55
    s_lshr_b64 s[46:47], s[62:63], s53
    s_and_b32 s55, s46, 3
    s_mul_i32 s52, s52, 221184
    s_mul_i32 s55, s55, 73728
    s_add_u32 s52, s52, s55
    s_lshr_b64 s[46:47], s[44:45], s53
    s_and_b32 s55, s46, 3
    s_mul_i32 s54, s54, 3
    s_add_u32 s54, s54, s55
    s_lshl_b32 s54, s54, 7
    s_add_u32 s52, s52, s54
    s_add_u32 s52, s52, s39
    buffer_load_dword v255, v9, s[40:43], s52 offen
L_ht31:
    s_add_u32 s52, s38, 32
    s_cmp_ge_u32 s52, 81
    s_cbranch_scc1 L_ht32
    s_mul_i32 s53, s52, 21846
    s_lshr_b32 s53, s53, 16
    s_mul_i32 s54, s53, 3
    s_sub_u32 s54, s52, s54
    s_lshl_b32 s53, s53, 1
    s_lshr_b64 s[46:47], s[60:61], s53
    s_and_b32 s52, s46, 3
    s_add_u32 s52, s52, s54
    s_cmp_ge_u32 s52, 3
    s_cselect_b32 s55, 3, 0
    s_sub_u32 s52, s52, s55
    s_lshr_b64 s[46:47], s[62:63], s53
    s_and_b32 s55, s46, 3
    s_mul_i32 s52, s52, 221184
    s_mul_i32 s55, s55, 73728
    s_add_u32 s52, s52, s55
    s_lshr_b64 s[46:47], s[44:45], s53
    s_and_b32 s55, s46, 3
    s_mul_i32 s54, s54, 3
    s_add_u32 s54, s54, s55
    s_lshl_b32 s54, s54, 7
    s_add_u32 s52, s52, s54
    s_add_u32 s52, s52, s39
    buffer_load_dword v255, v9, s[40:43], s52 offen
L_ht32:
    s_add_u32 s52, s38, 48
    s_cmp_ge_u32 s52, 81
    s_cbranch_scc1 L_ht33
    s_mul_i32 s53, s52, 21846
    s_lshr_b32 s53, s53, 16
    s_mul_i32 s54, s53, 3
    s_sub_u32 s54, s52, s54
    s_lshl_b32 s53, s53, 1
    s_lshr_b64 s[46:47], s[60:61], s53
    s_and_b32 s52, s46, 3
    s_add_u32 s52, s52, s54
    s_cmp_ge_u32 s52, 3
    s_cselect_b32 s55, 3, 0
    s_sub_u32 s52, s52, s55
    s_lshr_b64 s[46:47], s[62:63], s53
    s_and_b32 s55, s46, 3
    s_mul_i32 s52, s52, 221184
    s_mul_i32 s55, s55, 73728
    s_add_u32 s52, s52, s55
    s_lshr_b64 s[46:47], s[44:45], s53
    s_and_b32 s55, s46, 3
    s_mul_i32 s54, s54, 3
    s_add_u32 s54, s54, s55
    s_lshl_b32 s54, s54, 7
    s_add_u32 s52, s52, s54
    s_add_u32 s52, s52, s39
    buffer_load_dword v255, v9, s[40:43], s52 offen
L_ht33:
    s_add_u32 s52, s38, 64
    s_cmp_ge_u32 s52, 81
    s_cbranch_scc1 L_ht34
    s_mul_i32 s53, s52, 21846
    s_lshr_b32 s53, s53, 16
    s_mul_i32 s54, s53, 3
    s_sub_u32 s54, s52, s54
    s_lshl_b32 s53, s53, 1
    s_lshr_b64 s[46:47], s[60:61], s53
    s_and_b32 s52, s46, 3
    s_add_u32 s52, s52, s54
    s_cmp_ge_u32 s52, 3
    s_cselect_b32 s55, 3, 0
    s_sub_u32 s52, s52, s55
    s_lshr_b64 s[46:47], s[62:63], s53
    s_and_b32 s55, s46, 3
    s_mul_i32 s52, s52, 221184
    s_mul_i32 s55, s55, 73728
    s_add_u32 s52, s52, s55
    s_lshr_b64 s[46:47], s[44:45], s53
    s_and_b32 s55, s46, 3
    s_mul_i32 s54, s54, 3
    s_add_u32 s54, s54, s55
    s_lshl_b32 s54, s54, 7
    s_add_u32 s52, s52, s54
    s_add_u32 s52, s52, s39
    buffer_load_dword v255, v9, s[40:43], s52 offen
L_ht34:
    s_add_u32 s52, s38, 80
    s_cmp_ge_u32 s52, 81
    s_cbranch_scc1 L_ht35
    s_mul_i32 s53, s52, 21846
    s_lshr_b32 s53, s53, 16
    s_mul_i32 s54, s53, 3
    s_sub_u32 s54, s52, s54
    s_lshl_b32 s53, s53, 1
    s_lshr_b64 s[46:47], s[60:61], s53
    s_and_b32 s52, s46, 3
    s_add_u32 s52, s52, s54
    s_cmp_ge_u32 s52, 3
    s_cselect_b32 s55, 3, 0
    s_sub_u32 s52, s52, s55
    s_lshr_b64 s[46:47], s[62:63], s53
    s_and_b32 s55, s46, 3
    s_mul_i32 s52, s52, 221184
    s_mul_i32 s55, s55, 73728
    s_add_u32 s52, s52, s55
    s_lshr_b64 s[46:47], s[44:45], s53
    s_and_b32 s55, s46, 3
    s_mul_i32 s54, s54, 3
    s_add_u32 s54, s54, s55
    s_lshl_b32 s54, s54, 7
    s_add_u32 s52, s52, s54
    s_add_u32 s52, s52, s39
    buffer_load_dword v255, v9, s[40:43], s52 offen
L_ht35:
    s_branch L_end
L_tail_w:
    s_setprio 1
    s_lshl_b32 s52, s34, 7
    s_add_u32 s52, s52, 163577856
    s_load_dword s6, s[30:31], s52
    s_lshl_b32 s52, s57, 5
    v_add_u32 v8, s52, v2
    v_mul_u32_u24 v8, 1152, v8
    v_add_u32 v8, v8, v3
    v_add_u32 v9, 8192, v8
    v_add_u32 v10, 16384, v8
    v_add_u32 v11, 24576, v8
    s_mul_i32 s39, s32, 663552
    s_mul_i32 s52, s35, 384
    s_add_u32 s39, s39, s52
    s_add_u32 s53, s35, 0
    s_cmp_ge_u32 s53, 3
    s_cselect_b32 s54, 3, 0
    s_sub_u32 s53, s53, s54
    s_mul_i32 s53, s53, 221184
    s_add_u32 s62, s39, s53
    s_add_u32 s53, s35, 1
    s_cmp_ge_u32 s53, 3
    s_cselect_b32 s54, 3, 0
    s_sub_u32 s53, s53, s54
    s_mul_i32 s53, s53, 221184
    s_add_u32 s63, s39, s53
    s_add_u32 s53, s35, 2
    s_cmp_ge_u32 s53, 3
    s_cselect_b32 s54, 3, 0
    s_sub_u32 s53, s53, s54
    s_mul_i32 s53, s53, 221184
    s_add_u32 s59, s39, s53
    s_mov_b32 s44, s22
    s_mov_b32 s45, s23
    s_mov_b32 s46, 5308416
    s_mov_b32 s47, 0x00020000
    s_add_u32 m0, s56, 24576
    s_add_u32 s52, s38, 589824
    buffer_load_dwordx4 v4, s[40:43], s52 offen offset:0  lds
    buffer_load_dwordx4 v5, s[40:43], s52 offen offset:1024  lds
    buffer_load_dwordx4 v6, s[40:43], s52 offen offset:2048  lds
    buffer_load_dwordx4 v7, s[40:43], s52 offen offset:3072  lds
    s_add_u32 m0, s56, 32768
    s_add_u32 s52, s38, 589952
    buffer_load_dwordx4 v4, s[40:43], s52 offen offset:0  lds
    buffer_load_dwordx4 v5, s[40:43], s52 offen offset:1024  lds
    buffer_load_dwordx4 v6, s[40:43], s52 offen offset:2048  lds
    buffer_load_dwordx4 v7, s[40:43], s52 offen offset:3072  lds
    s_add_u32 m0, s56, 40960
    s_add_u32 s52, s38, 590080
    buffer_load_dwordx4 v4, s[40:43], s52 offen offset:0  lds
    buffer_load_dwordx4 v5, s[40:43], s52 offen offset:1024  lds
    buffer_load_dwordx4 v6, s[40:43], s52 offen offset:2048  lds
    buffer_load_dwordx4 v7, s[40:43], s52 offen offset:3072  lds
    s_waitcnt vmcnt(12)
    s_barrier
    s_add_u32 m0, s56, 49152
    s_add_u32 s52, s38, 1179648
    buffer_load_dwordx4 v4, s[40:43], s52 offen offset:0  lds
    buffer_load_dwordx4 v5, s[40:43], s52 offen offset:1024  lds
    buffer_load_dwordx4 v6, s[40:43], s52 offen offset:2048  lds
    buffer_load_dwordx4 v7, s[40:43], s52 offen offset:3072  lds
    s_add_u32 m0, s56, 57344
    s_add_u32 s52, s38, 1179776
    buffer_load_dwordx4 v4, s[40:43], s52 offen offset:0  lds
    buffer_load_dwordx4 v5, s[40:43], s52 offen offset:1024  lds
    buffer_load_dwordx4 v6, s[40:43], s52 offen offset:2048  lds
    buffer_load_dwordx4 v7, s[40:43], s52 offen offset:3072  lds
    s_add_u32 m0, s56, 65536
    s_add_u32 s52, s38, 1179904
    buffer_load_dwordx4 v4, s[40:43], s52 offen offset:0  lds
    buffer_load_dwordx4 v5, s[40:43], s52 offen offset:1024  lds
    buffer_load_dwordx4 v6, s[40:43], s52 offen offset:2048  lds
    buffer_load_dwordx4 v7, s[40:43], s52 offen offset:3072  lds
    s_waitcnt vmcnt(12)
    s_barrier
    s_add_u32 m0, s56, 73728
    s_add_u32 s52, s38, 1769472
    buffer_load_dwordx4 v4, s[40:43], s52 offen offset:0  lds
    buffer_load_dwordx4 v5, s[40:43], s52 offen offset:1024  lds
    buffer_load_dwordx4 v6, s[40:43], s52 offen offset:2048  lds
    buffer_load_dwordx4 v7, s[40:43], s52 offen offset:3072  lds
    s_add_u32 m0, s56, 81920
    s_add_u32 s52, s38, 1769600
    buffer_load_dwordx4 v4, s[40:43], s52 offen offset:0  lds
    buffer_load_dwordx4 v5, s[40:43], s52 offen offset:1024  lds
    buffer_load_dwordx4 v6, s[40:43], s52 offen offset:2048  lds
    buffer_load_dwordx4 v7, s[40:43], s52 offen offset:3072  lds
    s_add_u32 m0, s56, 90112
    s_add_u32 s52, s38, 1769728
    buffer_load_dwordx4 v4, s[40:43], s52 offen offset:0  lds
    buffer_load_dwordx4 v5, s[40:43], s52 offen offset:1024  lds
    buffer_load_dwordx4 v6, s[40:43], s52 offen offset:2048  lds
    buffer_load_dwordx4 v7, s[40:43], s52 offen offset:3072  lds
    s_waitcnt vmcnt(12)
    s_waitcnt lgkmcnt(0)
    s_add_u32 s6, s6, 1
    s_mul_i32 s7, s6, 0x22222222
    s_and_b32 s7, s7, 0xeeeeeeee
    s_or_b32 s7, s7, 0x10101010
    s_barrier
    s_add_u32 m0, s56, 98304
    s_add_u32 s52, s38, 2359296
    buffer_load_dwordx4 v4, s[40:43], s52 offen offset:0  lds
    buffer_load_dwordx4 v5, s[40:43], s52 offen offset:1024  lds
    buffer_load_dwordx4 v6, s[40:43], s52 offen offset:2048  lds
    buffer_load_dwordx4 v7, s[40:43], s52 offen offset:3072  lds
    s_add_u32 m0, s56, 106496
    s_add_u32 s52, s38, 2359424
    buffer_load_dwordx4 v4, s[40:43], s52 offen offset:0  lds
    buffer_load_dwordx4 v5, s[40:43], s52 offen offset:1024  lds
    buffer_load_dwordx4 v6, s[40:43], s52 offen offset:2048  lds
    buffer_load_dwordx4 v7, s[40:43], s52 offen offset:3072  lds
    s_add_u32 m0, s56, 114688
    s_add_u32 s52, s38, 2359552
    buffer_load_dwordx4 v4, s[40:43], s52 offen offset:0  lds
    buffer_load_dwordx4 v5, s[40:43], s52 offen offset:1024  lds
    buffer_load_dwordx4 v6, s[40:43], s52 offen offset:2048  lds
    buffer_load_dwordx4 v7, s[40:43], s52 offen offset:3072  lds
    s_waitcnt vmcnt(12)
    s_barrier
    s_add_u32 m0, s56, 122880
    s_add_u32 s52, s38, 2949120
    buffer_load_dwordx4 v4, s[40:43], s52 offen offset:0  lds
    buffer_load_dwordx4 v5, s[40:43], s52 offen offset:1024  lds
    buffer_load_dwordx4 v6, s[40:43], s52 offen offset:2048  lds
    buffer_load_dwordx4 v7, s[40:43], s52 offen offset:3072  lds
    s_add_u32 m0, s56, 0
    s_add_u32 s52, s38, 2949248
    buffer_load_dwordx4 v4, s[40:43], s52 offen offset:0  lds
    buffer_load_dwordx4 v5, s[40:43], s52 offen offset:1024  lds
    buffer_load_dwordx4 v6, s[40:43], s52 offen offset:2048  lds
    buffer_load_dwordx4 v7, s[40:43], s52 offen offset:3072  lds
    s_add_u32 m0, s56, 8192
    s_add_u32 s52, s38, 2949376
    buffer_load_dwordx4 v4, s[40:43], s52 offen offset:0  lds
    buffer_load_dwordx4 v5, s[40:43], s52 offen offset:1024  lds
    buffer_load_dwordx4 v6, s[40:43], s52 offen offset:2048  lds
    buffer_load_dwordx4 v7, s[40:43], s52 offen offset:3072  lds
    s_waitcnt vmcnt(12)
    s_barrier
    s_add_u32 m0, s56, 40960
    s_add_u32 s52, s38, 3538944
    buffer_load_dwordx4 v4, s[40:43], s52 offen offset:0  lds
    buffer_load_dwordx4 v5, s[40:43], s52 offen offset:1024  lds
    buffer_load_dwordx4 v6, s[40:43], s52 offen offset:2048  lds
    buffer_load_dwordx4 v7, s[40:43], s52 offen offset:3072  lds
    s_add_u32 m0, s56, 49152
    s_add_u32 s52, s38, 3539072
    buffer_load_dwordx4 v4, s[40:43], s52 offen offset:0  lds
    buffer_load_dwordx4 v5, s[40:43], s52 offen offset:1024  lds
    buffer_load_dwordx4 v6, s[40:43], s52 offen offset:2048  lds
    buffer_load_dwordx4 v7, s[40:43], s52 offen offset:3072  lds
    s_add_u32 m0, s56, 57344
    s_add_u32 s52, s38, 3539200
    buffer_load_dwordx4 v4, s[40:43], s52 offen offset:0  lds
    buffer_load_dwordx4 v5, s[40:43], s52 offen offset:1024  lds
    buffer_load_dwordx4 v6, s[40:43], s52 offen offset:2048  lds
    buffer_load_dwordx4 v7, s[40:43], s52 offen offset:3072  lds
    s_waitcnt vmcnt(12)
    s_barrier
    s_add_u32 m0, s56, 65536
    s_add_u32 s52, s38, 4128768
    buffer_load_dwordx4 v4, s[40:43], s52 offen offset:0  lds
    buffer_load_dwordx4 v5, s[40:43], s52 offen offset:1024  lds
    buffer_load_dwordx4 v6, s[40:43], s52 offen offset:2048  lds
    buffer_load_dwordx4 v7, s[40:43], s52 offen offset:3072  lds
    s_add_u32 m0, s56, 73728
    s_add_u32 s52, s38, 4128896
    buffer_load_dwordx4 v4, s[40:43], s52 offen offset:0  lds
    buffer_load_dwordx4 v5, s[40:43], s52 offen offset:1024  lds
    buffer_load_dwordx4 v6, s[40:43], s52 offen offset:2048  lds
    buffer_load_dwordx4 v7, s[40:43], s52 offen offset:3072  lds
    s_add_u32 m0, s56, 81920
    s_add_u32 s52, s38, 4129024
    buffer_load_dwordx4 v4, s[40:43], s52 offen offset:0  lds
    buffer_load_dwordx4 v5, s[40:43], s52 offen offset:1024  lds
    buffer_load_dwordx4 v6, s[40:43], s52 offen offset:2048  lds
    buffer_load_dwordx4 v7, s[40:43], s52 offen offset:3072  lds
    s_waitcnt vmcnt(12)
    s_barrier
    s_add_u32 m0, s56, 90112
    s_add_u32 s52, s38, 4718592
    buffer_load_dwordx4 v4, s[40:43], s52 offen offset:0  lds
    buffer_load_dwordx4 v5, s[40:43], s52 offen offset:1024  lds
    buffer_load_dwordx4 v6, s[40:43], s52 offen offset:2048  lds
    buffer_load_dwordx4 v7, s[40:43], s52 offen offset:3072  lds
    s_add_u32 m0, s56, 98304
    s_add_u32 s52, s38, 4718720
    buffer_load_dwordx4 v4, s[40:43], s52 offen offset:0  lds
    buffer_load_dwordx4 v5, s[40:43], s52 offen offset:1024  lds
    buffer_load_dwordx4 v6, s[40:43], s52 offen offset:2048  lds
    buffer_load_dwordx4 v7, s[40:43], s52 offen offset:3072  lds
    s_add_u32 m0, s56, 106496
    s_add_u32 s52, s38, 4718848
    buffer_load_dwordx4 v4, s[40:43], s52 offen offset:0  lds
    buffer_load_dwordx4 v5, s[40:43], s52 offen offset:1024  lds
    buffer_load_dwordx4 v6, s[40:43], s52 offen offset:2048  lds
    buffer_load_dwordx4 v7, s[40:43], s52 offen offset:3072  lds
    s_waitcnt vmcnt(12)
    s_barrier
    s_add_u32 m0, s56, 114688
    s_add_u32 s52, s62, 0
    buffer_load_dwordx4 v8, s[44:47], s52 offen offset:0  lds
    buffer_load_dwordx4 v9, s[44:47], s52 offen offset:1024  lds
    buffer_load_dwordx4 v10, s[44:47], s52 offen offset:2048  lds
    buffer_load_dwordx4 v11, s[44:47], s52 offen offset:3072  lds
    s_add_u32 m0, s56, 0
    s_add_u32 s52, s62, 128
    buffer_load_dwordx4 v8, s[44:47], s52 offen offset:0  lds
    buffer_load_dwordx4 v9, s[44:47], s52 offen offset:1024  lds
    buffer_load_dwordx4 v10, s[44:47], s52 offen offset:2048  lds
    buffer_load_dwordx4 v11, s[44:47], s52 offen offset:3072  lds
    s_add_u32 m0, s56, 8192
    s_add_u32 s52, s62, 256
    buffer_load_dwordx4 v8, s[44:47], s52 offen offset:0  lds
    buffer_load_dwordx4 v9, s[44:47], s52 offen offset:1024  lds
    buffer_load_dwordx4 v10, s[44:47], s52 offen offset:2048  lds
    buffer_load_dwordx4 v11, s[44:47], s52 offen offset:3072  lds
    s_add_u32 m0, s56, 122880
    s_add_u32 s52, s62, 73728
    buffer_load_dwordx4 v8, s[44:47], s52 offen offset:0  lds
    buffer_load_dwordx4 v9, s[44:47], s52 offen offset:1024  lds
    buffer_load_dwordx4 v10, s[44:47], s52 offen offset:2048  lds
    buffer_load_dwordx4 v11, s[44:47], s52 offen offset:3072  lds
    s_waitcnt vmcnt(16)
    s_barrier
    s_add_u32 m0, s56, 139264
    s_add_u32 s52, s62, 73856
    buffer_load_dwordx4 v8, s[44:47], s52 offen offset:0  lds
    buffer_load_dwordx4 v9, s[44:47], s52 offen offset:1024  lds
    buffer_load_dwordx4 v10, s[44:47], s52 offen offset:2048  lds
    buffer_load_dwordx4 v11, s[44:47], s52 offen offset:3072  lds
    s_add_u32 m0, s56, 40960
    s_add_u32 s52, s62, 73984
    buffer_load_dwordx4 v8, s[44:47], s52 offen offset:0  lds
    buffer_load_dwordx4 v9, s[44:47], s52 offen offset:1024  lds
    buffer_load_dwordx4 v10, s[44:47], s52 offen offset:2048  lds
    buffer_load_dwordx4 v11, s[44:47], s52 offen offset:3072  lds
    s_add_u32 m0, s56, 49152
    s_add_u32 s52, s62, 147456
    buffer_load_dwordx4 v8, s[44:47], s52 offen offset:0  lds
    buffer_load_dwordx4 v9, s[44:47], s52 offen offset:1024  lds
    buffer_load_dwordx4 v10, s[44:47], s52 offen offset:2048  lds
    buffer_load_dwordx4 v11, s[44:47], s52 offen offset:3072  lds
    s_add_u32 m0, s56, 57344
    s_add_u32 s52, s62, 147584
    buffer_load_dwordx4 v8, s[44:47], s52 offen offset:0  lds
    buffer_load_dwordx4 v9, s[44:47], s52 offen offset:1024  lds
    buffer_load_dwordx4 v10, s[44:47], s52 offen offset:2048  lds
    buffer_load_dwordx4 v11, s[44:47], s52 offen offset:3072  lds
    s_add_u32 m0, s56, 147456
    s_add_u32 s52, s62, 147712
    buffer_load_dwordx4 v8, s[44:47], s52 offen offset:0  lds
    buffer_load_dwordx4 v9, s[44:47], s52 offen offset:1024  lds
    buffer_load_dwordx4 v10, s[44:47], s52 offen offset:2048  lds
    buffer_load_dwordx4 v11, s[44:47], s52 offen offset:3072  lds
    s_waitcnt vmcnt(24)
    s_sub_u32 s13, s36, 4
    v_lshlrev_b32 v64, 3, v1
    s_lshl_b32 s61, s13, 6
    s_lshr_b32 s60, s13, 1
    s_mul_i32 s60, s60, 65536
    s_and_b32 s53, s13, 1
    s_lshl_b32 s53, s53, 9
    s_add_u32 s60, s60, s53
    v_lshrrev_b32 v112, 4, v1
    v_and_b32 v113, 1, v1
    v_lshlrev_b32 v113, 3, v113
    v_lshl_add_u32 v112, v112, 4, v113
    v_bfe_u32 v114, v1, 1, 3
    v_and_b32 v115, 7, v1
    v_lshlrev_b32 v115, 2, v115
    s_mul_i32 s53, s35, 384
    s_add_u32 s61, s61, s53
    s_mov_b32 s48, s24
    s_mov_b32 s49, s25
    s_mov_b32 s50, 1152
    s_mov_b32 s51, 0x00020000
    buffer_load_dwordx2 v[66:67], v112, s[48:51], s61 offen
    s_lshl_b32 s53, s32, 3
    s_lshl_b32 s55, s34, 6
    s_add_u32 s53, s53, s55
    s_mul_i32 s53, s53, 1152
    s_add_u32 s61, s61, s53
    v_mul_u32_u24 v114, 1152, v114
    v_add_u32 v65, v112, v114
    s_mul_i32 s53, s33, 196608
    s_add_u32 s60, s60, s53
    s_mul_i32 s53, s32, 8192
    s_add_u32 s60, s60, s53
    s_add_u32 s60, s60, 155713536
    v_mov_b32 v117, 0
    v_lshrrev_b32 v115, v115, s7
    v_bfe_u32 v120, v115, 0, 2
    v_mul_u32_u24 v120, 0x8001, v120
    v_bfe_u32 v121, v115, 2, 2
    v_mul_u32_u24 v121, 0x8001, v121
    v_mov_b32 v124, 0x10001
    v_mov_b32 v125, 0xffff0000
    s_barrier
    s_waitcnt vmcnt(13)
    s_barrier
    s_add_u32 m0, s56, 81920
    s_add_u32 s52, s63, 0
    buffer_load_dwordx4 v8, s[44:47], s52 offen offset:0  lds
    buffer_load_dwordx4 v9, s[44:47], s52 offen offset:1024  lds
    buffer_load_dwordx4 v10, s[44:47], s52 offen offset:2048  lds
    buffer_load_dwordx4 v11, s[44:47], s52 offen offset:3072  lds
    s_add_u32 m0, s56, 155648
    s_add_u32 s52, s63, 128
    buffer_load_dwordx4 v8, s[44:47], s52 offen offset:0  lds
    buffer_load_dwordx4 v9, s[44:47], s52 offen offset:1024  lds
    buffer_load_dwordx4 v10, s[44:47], s52 offen offset:2048  lds
    buffer_load_dwordx4 v11, s[44:47], s52 offen offset:3072  lds
    s_add_u32 m0, s56, 90112
    s_add_u32 s52, s59, 0
    buffer_load_dwordx4 v8, s[44:47], s52 offen offset:0  lds
    buffer_load_dwordx4 v9, s[44:47], s52 offen offset:1024  lds
    buffer_load_dwordx4 v10, s[44:47], s52 offen offset:2048  lds
    buffer_load_dwordx4 v11, s[44:47], s52 offen offset:3072  lds
    s_add_u32 m0, s56, 106496
    s_add_u32 s52, s59, 128
    buffer_load_dwordx4 v8, s[44:47], s52 offen offset:0  lds
    buffer_load_dwordx4 v9, s[44:47], s52 offen offset:1024  lds
    buffer_load_dwordx4 v10, s[44:47], s52 offen offset:2048  lds
    buffer_load_dwordx4 v11, s[44:47], s52 offen offset:3072  lds
    s_waitcnt vmcnt(17)
    s_barrier
    s_add_u32 m0, s56, 131072
    s_add_u32 s52, s63, 73728
    buffer_load_dwordx4 v8, s[44:47], s52 offen offset:0  lds
    buffer_load_dwordx4 v9, s[44:47], s52 offen offset:1024  lds
    buffer_load_dwordx4 v10, s[44:47], s52 offen offset:2048  lds
    buffer_load_dwordx4 v11, s[44:47], s52 offen offset:3072  lds
    s_add_u32 m0, s56, 0
    s_add_u32 s52, s63, 73856
    buffer_load_dwordx4 v8, s[44:47], s52 offen offset:0  lds
    buffer_load_dwordx4 v9, s[44:47], s52 offen offset:1024  lds
    buffer_load_dwordx4 v10, s[44:47], s52 offen offset:2048  lds
    buffer_load_dwordx4 v11, s[44:47], s52 offen offset:3072  lds
    s_add_u32 m0, s56, 114688
    s_add_u32 s52, s59, 73728
    buffer_load_dwordx4 v8, s[44:47], s52 offen offset:0  lds
    buffer_load_dwordx4 v9, s[44:47], s52 offen offset:1024  lds
    buffer_load_dwordx4 v10, s[44:47], s52 offen offset:2048  lds
    buffer_load_dwordx4 v11, s[44:47], s52 offen offset:3072  lds
    s_waitcnt vmcnt(16)
    v_lshlrev_b32 v72, 16, v66
    v_and_b32 v73, v125, v66
    v_lshlrev_b32 v74, 16, v67
    v_and_b32 v75, v125, v67
    s_barrier
    s_add_u32 m0, s56, 24576
    s_add_u32 s52, s59, 73856
    buffer_load_dwordx4 v8, s[44:47], s52 offen offset:0  lds
    buffer_load_dwordx4 v9, s[44:47], s52 offen offset:1024  lds
    buffer_load_dwordx4 v10, s[44:47], s52 offen offset:2048  lds
    buffer_load_dwordx4 v11, s[44:47], s52 offen offset:3072  lds
    s_add_u32 m0, s56, 40960
    s_add_u32 s52, s63, 147456
    buffer_load_dwordx4 v8, s[44:47], s52 offen offset:0  lds
    buffer_load_dwordx4 v9, s[44:47], s52 offen offset:1024  lds
    buffer_load_dwordx4 v10, s[44:47], s52 offen offset:2048  lds
    buffer_load_dwordx4 v11, s[44:47], s52 offen offset:3072  lds
    s_add_u32 m0, s56, 139264
    s_add_u32 s52, s59, 147456
    buffer_load_dwordx4 v8, s[44:47], s52 offen offset:0  lds
    buffer_load_dwordx4 v9, s[44:47], s52 offen offset:1024  lds
    buffer_load_dwordx4 v10, s[44:47], s52 offen offset:2048  lds
    buffer_load_dwordx4 v11, s[44:47], s52 offen offset:3072  lds
    s_waitcnt vmcnt(16)
    s_barrier
    s_add_u32 m0, s56, 32768
    s_add_u32 s52, s63, 147584
    buffer_load_dwordx4 v8, s[44:47], s52 offen offset:0  lds
    buffer_load_dwordx4 v9, s[44:47], s52 offen offset:1024  lds
    buffer_load_dwordx4 v10, s[44:47], s52 offen offset:2048  lds
    buffer_load_dwordx4 v11, s[44:47], s52 offen offset:3072  lds
    s_add_u32 m0, s56, 49152
    s_add_u32 s52, s59, 147584
    buffer_load_dwordx4 v8, s[44:47], s52 offen offset:0  lds
    buffer_load_dwordx4 v9, s[44:47], s52 offen offset:1024  lds
    buffer_load_dwordx4 v10, s[44:47], s52 offen offset:2048  lds
    buffer_load_dwordx4 v11, s[44:47], s52 offen offset:3072  lds
    s_add_u32 m0, s56, 57344
    s_add_u32 s52, s63, 256
    buffer_load_dwordx4 v8, s[44:47], s52 offen offset:0  lds
    buffer_load_dwordx4 v9, s[44:47], s52 offen offset:1024  lds
    buffer_load_dwordx4 v10, s[44:47], s52 offen offset:2048  lds
    buffer_load_dwordx4 v11, s[44:47], s52 offen offset:3072  lds
    s_add_u32 m0, s56, 147456
    s_add_u32 s52, s59, 256
    buffer_load_dwordx4 v8, s[44:47], s52 offen offset:0  lds
    buffer_load_dwordx4 v9, s[44:47], s52 offen offset:1024  lds
    buffer_load_dwordx4 v10, s[44:47], s52 offen offset:2048  lds
    buffer_load_dwordx4 v11, s[44:47], s52 offen offset:3072  lds
    s_waitcnt vmcnt(20)
    s_barrier
    s_add_u32 m0, s56, 65536
    s_add_u32 s52, s63, 73984
    buffer_load_dwordx4 v8, s[44:47], s52 offen offset:0  lds
    buffer_load_dwordx4 v9, s[44:47], s52 offen offset:1024  lds
    buffer_load_dwordx4 v10, s[44:47], s52 offen offset:2048  lds
    buffer_load_dwordx4 v11, s[44:47], s52 offen offset:3072  lds
    s_add_u32 m0, s56, 73728
    s_add_u32 s52, s59, 73984
    buffer_load_dwordx4 v8, s[44:47], s52 offen offset:0  lds
    buffer_load_dwordx4 v9, s[44:47], s52 offen offset:1024  lds
    buffer_load_dwordx4 v10, s[44:47], s52 offen offset:2048  lds
    buffer_load_dwordx4 v11, s[44:47], s52 offen offset:3072  lds
    s_add_u32 m0, s56, 81920
    s_add_u32 s52, s63, 147712
    buffer_load_dwordx4 v8, s[44:47], s52 offen offset:0  lds
    buffer_load_dwordx4 v9, s[44:47], s52 offen offset:1024  lds
    buffer_load_dwordx4 v10, s[44:47], s52 offen offset:2048  lds
    buffer_load_dwordx4 v11, s[44:47], s52 offen offset:3072  lds
    s_add_u32 m0, s56, 90112
    s_add_u32 s52, s59, 147712
    buffer_load_dwordx4 v8, s[44:47], s52 offen offset:0  lds
    buffer_load_dwordx4 v9, s[44:47], s52 offen offset:1024  lds
    buffer_load_dwordx4 v10, s[44:47], s52 offen offset:2048  lds
    buffer_load_dwordx4 v11, s[44:47], s52 offen offset:3072  lds
    s_waitcnt vmcnt(24)
    s_barrier
    s_waitcnt vmcnt(12)
    s_barrier
    s_waitcnt vmcnt(0)
    s_barrier
    s_branch L_reduce
    .fill 43, 4, 0xbf800000
L_tail_x:
    s_setprio 1
    v_lshlrev_b32 v12, 4, v1
    v_add_u32 v13, 0x10000, v12
    v_add_u32 v14, 0x20000, v12
    s_sub_u32 s52, s37, s35
    s_add_u32 s53, s35, 1
    s_cmp_ge_u32 s53, 3
    s_cselect_b32 s54, 3, 0
    s_sub_u32 s53, s53, s54
    s_add_u32 s53, s53, s52
    s_mul_i32 s39, s53, 24576
    s_add_u32 s53, s35, 2
    s_cmp_ge_u32 s53, 3
    s_cselect_b32 s54, 3, 0
    s_sub_u32 s53, s53, s54
    s_add_u32 s53, s53, s52
    s_mul_i32 s59, s53, 24576
    s_mov_b32 s44, s30
    s_mov_b32 s45, s31
    s_mov_b32 s46, 268435456
    s_mov_b32 s47, 0x00020000
    s_lshl_b32 s52, s34, 7
    s_add_u32 s52, s52, 163577856
    s_load_dword s6, s[30:31], s52
    s_mov_b32 m0, 139264
    s_add_u32 s52, s38, 128
    buffer_load_dwordx4 v8, s[40:43], s52 offen offset:0 lds
    buffer_load_dwordx4 v9, s[40:43], s52 offen offset:1024 lds
    buffer_load_dwordx4 v10, s[40:43], s52 offen offset:2048 lds
    buffer_load_dwordx4 v11, s[40:43], s52 offen offset:3072 lds
    s_mov_b32 m0, 143360
    s_add_u32 s52, s38, 36992
    buffer_load_dwordx4 v8, s[40:43], s52 offen offset:0 lds
    buffer_load_dwordx4 v9, s[40:43], s52 offen offset:1024 lds
    buffer_load_dwordx4 v10, s[40:43], s52 offen offset:2048 lds
    buffer_load_dwordx4 v11, s[40:43], s52 offen offset:3072 lds
    s_waitcnt vmcnt(8)
    s_barrier
    s_mov_b32 m0, 147456
    s_add_u32 s52, s38, 256
    buffer_load_dwordx4 v8, s[40:43], s52 offen offset:0 lds
    buffer_load_dwordx4 v9, s[40:43], s52 offen offset:1024 lds
    buffer_load_dwordx4 v10, s[40:43], s52 offen offset:2048 lds
    buffer_load_dwordx4 v11, s[40:43], s52 offen offset:3072 lds
    s_mov_b32 m0, 151552
    s_add_u32 s52, s38, 37120
    buffer_load_dwordx4 v8, s[40:43], s52 offen offset:0 lds
    buffer_load_dwordx4 v9, s[40:43], s52 offen offset:1024 lds
    buffer_load_dwordx4 v10, s[40:43], s52 offen offset:2048 lds
    buffer_load_dwordx4 v11, s[40:43], s52 offen offset:3072 lds
    s_waitcnt vmcnt(8)
    s_barrier
    s_mov_b32 m0, 155648
    s_add_u32 s52, s38, 384
    buffer_load_dwordx4 v8, s[40:43], s52 offen offset:0 lds
    buffer_load_dwordx4 v9, s[40:43], s52 offen offset:1024 lds
    buffer_load_dwordx4 v10, s[40:43], s52 offen offset:2048 lds
    buffer_load_dwordx4 v11, s[40:43], s52 offen offset:3072 lds
    s_mov_b32 m0, 159744
    s_add_u32 s52, s38, 37248
    buffer_load_dwordx4 v8, s[40:43], s52 offen offset:0 lds
    buffer_load_dwordx4 v9, s[40:43], s52 offen offset:1024 lds
    buffer_load_dwordx4 v10, s[40:43], s52 offen offset:2048 lds
    buffer_load_dwordx4 v11, s[40:43], s52 offen offset:3072 lds
    s_waitcnt vmcnt(8)
    s_waitcnt lgkmcnt(0)
    s_add_u32 s6, s6, 1
    s_mul_i32 s7, s6, 0x22222222
    s_and_b32 s7, s7, 0xeeeeeeee
    s_or_b32 s7, s7, 0x10101010
    v_and_b32 v16, 3, v1
    v_lshlrev_b32 v16, 3, v16
    v_lshrrev_b32 v16, v16, s7
    v_bfe_u32 v25, v16, 0, 2
    v_mul_u32_u24 v25, 0x8001, v25
    v_and_b32 v25, 0x10001, v25
    v_lshl_or_b32 v25, v25, 15, v25
    v_bfe_u32 v26, v16, 2, 2
    v_mul_u32_u24 v26, 0x8001, v26
    v_and_b32 v26, 0x10001, v26
    v_lshl_or_b32 v26, v26, 15, v26
    v_bfe_u32 v27, v16, 4, 2
    v_mul_u32_u24 v27, 0x8001, v27
    v_and_b32 v27, 0x10001, v27
    v_lshl_or_b32 v27, v27, 15, v27
    v_bfe_u32 v28, v16, 6, 2
    v_mul_u32_u24 v28, 0x8001, v28
    v_and_b32 v28, 0x10001, v28
    v_lshl_or_b32 v28, v28, 15, v28
    v_mov_b32 v24, 65537
    s_mov_b32 s58, 0
    s_barrier
    s_mov_b32 m0, 131072
    s_add_u32 s52, s38, 512
    buffer_load_dwordx4 v8, s[40:43], s52 offen offset:0 lds
    buffer_load_dwordx4 v9, s[40:43], s52 offen offset:1024 lds
    buffer_load_dwordx4 v10, s[40:43], s52 offen offset:2048 lds
    buffer_load_dwordx4 v11, s[40:43], s52 offen offset:3072 lds
    s_mov_b32 m0, 135168
    s_add_u32 s52, s38, 37376
    buffer_load_dwordx4 v8, s[40:43], s52 offen offset:0 lds
    buffer_load_dwordx4 v9, s[40:43], s52 offen offset:1024 lds
    buffer_load_dwordx4 v10, s[40:43], s52 offen offset:2048 lds
    buffer_load_dwordx4 v11, s[40:43], s52 offen offset:3072 lds
    s_waitcnt vmcnt(8)
    s_barrier
    s_mov_b32 m0, 139264
    s_add_u32 s52, s38, 640
    buffer_load_dwordx4 v8, s[40:43], s52 offen offset:0 lds
    buffer_load_dwordx4 v9, s[40:43], s52 offen offset:1024 lds
    buffer_load_dwordx4 v10, s[40:43], s52 offen offset:2048 lds
    buffer_load_dwordx4 v11, s[40:43], s52 offen offset:3072 lds
    s_mov_b32 m0, 143360
    s_add_u32 s52, s38, 37504
    buffer_load_dwordx4 v8, s[40:43], s52 offen offset:0 lds
    buffer_load_dwordx4 v9, s[40:43], s52 offen offset:1024 lds
    buffer_load_dwordx4 v10, s[40:43], s52 offen offset:2048 lds
    buffer_load_dwordx4 v11, s[40:43], s52 offen offset:3072 lds
    s_waitcnt vmcnt(8)
    s_barrier
    s_mov_b32 m0, 147456
    s_add_u32 s52, s38, 768
    buffer_load_dwordx4 v8, s[40:43], s52 offen offset:0 lds
    buffer_load_dwordx4 v9, s[40:43], s52 offen offset:1024 lds
    buffer_load_dwordx4 v10, s[40:43], s52 offen offset:2048 lds
    buffer_load_dwordx4 v11, s[40:43], s52 offen offset:3072 lds
    s_mov_b32 m0, 151552
    s_add_u32 s52, s38, 37632
    buffer_load_dwordx4 v8, s[40:43], s52 offen offset:0 lds
    buffer_load_dwordx4 v9, s[40:43], s52 offen offset:1024 lds
    buffer_load_dwordx4 v10, s[40:43], s52 offen offset:2048 lds
    buffer_load_dwordx4 v11, s[40:43], s52 offen offset:3072 lds
    s_waitcnt vmcnt(8)
    s_barrier
    s_mov_b32 m0, 155648
    s_add_u32 s52, s38, 896
    buffer_load_dwordx4 v8, s[40:43], s52 offen offset:0 lds
    buffer_load_dwordx4 v9, s[40:43], s52 offen offset:1024 lds
    buffer_load_dwordx4 v10, s[40:43], s52 offen offset:2048 lds
    buffer_load_dwordx4 v11, s[40:43], s52 offen offset:3072 lds
    s_mov_b32 m0, 159744
    s_add_u32 s52, s38, 37760
    buffer_load_dwordx4 v8, s[40:43], s52 offen offset:0 lds
    buffer_load_dwordx4 v9, s[40:43], s52 offen offset:1024 lds
    buffer_load_dwordx4 v10, s[40:43], s52 offen offset:2048 lds
    buffer_load_dwordx4 v11, s[40:43], s52 offen offset:3072 lds
    s_waitcnt vmcnt(8)
    s_barrier
    s_mov_b32 m0, 131072
    s_add_u32 s52, s38, 1024
    buffer_load_dwordx4 v8, s[40:43], s52 offen offset:0 lds
    buffer_load_dwordx4 v9, s[40:43], s52 offen offset:1024 lds
    buffer_load_dwordx4 v10, s[40:43], s52 offen offset:2048 lds
    buffer_load_dwordx4 v11, s[40:43], s52 offen offset:3072 lds
    s_mov_b32 m0, 135168
    s_add_u32 s52, s38, 37888
    buffer_load_dwordx4 v8, s[40:43], s52 offen offset:0 lds
    buffer_load_dwordx4 v9, s[40:43], s52 offen offset:1024 lds
    buffer_load_dwordx4 v10, s[40:43], s52 offen offset:2048 lds
    buffer_load_dwordx4 v11, s[40:43], s52 offen offset:3072 lds
    s_waitcnt vmcnt(8)
    s_barrier
    s_waitcnt vmcnt(0)
    s_barrier
    s_sub_u32 s13, s36, 4
    v_lshlrev_b32 v64, 3, v1
    s_lshl_b32 s61, s13, 6
    s_lshr_b32 s60, s13, 1
    s_mul_i32 s60, s60, 65536
    s_and_b32 s53, s13, 1
    s_lshl_b32 s53, s53, 9
    s_add_u32 s60, s60, s53
    v_lshrrev_b32 v112, 4, v1
    v_and_b32 v113, 1, v1
    v_lshlrev_b32 v113, 3, v113
    v_lshl_add_u32 v112, v112, 4, v113
    v_bfe_u32 v114, v1, 1, 3
    v_and_b32 v115, 7, v1
    v_lshlrev_b32 v115, 2, v115
    s_mul_i32 s53, s35, 384
    s_add_u32 s61, s61, s53
    s_mov_b32 s48, s24
    s_mov_b32 s49, s25
    s_mov_b32 s50, 1152
    s_mov_b32 s51, 0x00020000
    buffer_load_dwordx2 v[66:67], v112, s[48:51], s61 offen
    s_lshl_b32 s53, s32, 3
    s_lshl_b32 s55, s34, 6
    s_add_u32 s53, s53, s55
    s_mul_i32 s53, s53, 1152
    s_add_u32 s61, s61, s53
    v_mul_u32_u24 v114, 1152, v114
    v_add_u32 v65, v112, v114
    s_mul_i32 s53, s33, 196608
    s_add_u32 s60, s60, s53
    s_mul_i32 s53, s32, 8192
    s_add_u32 s60, s60, s53
    s_add_u32 s60, s60, 155713536
    v_mov_b32 v117, 0
    v_lshrrev_b32 v115, v115, s7
    v_bfe_u32 v120, v115, 0, 2
    v_mul_u32_u24 v120, 0x8001, v120
    v_bfe_u32 v121, v115, 2, 2
    v_mul_u32_u24 v121, 0x8001, v121
    v_mov_b32 v124, 0x10001
    v_mov_b32 v125, 0xffff0000
    s_barrier
    s_barrier
    s_barrier
    s_mov_b32 m0, 65536
    s_add_u32 s52, s39, 150994944
    buffer_load_dwordx4 v12, s[44:47], s52 offen offset:0 sc1 lds
    buffer_load_dwordx4 v12, s[44:47], s52 offen offset:1024 sc1 lds
    buffer_load_dwordx4 v12, s[44:47], s52 offen offset:2048 sc1 lds
    buffer_load_dwordx4 v12, s[44:47], s52 offen offset:3072 sc1 lds
    s_mov_b32 m0, 73728
    s_add_u32 s52, s59, 150994944
    buffer_load_dwordx4 v12, s[44:47], s52 offen offset:0 sc1 lds
    buffer_load_dwordx4 v12, s[44:47], s52 offen offset:1024 sc1 lds
    buffer_load_dwordx4 v12, s[44:47], s52 offen offset:2048 sc1 lds
    buffer_load_dwordx4 v12, s[44:47], s52 offen offset:3072 sc1 lds
    s_mov_b32 m0, 98304
    s_add_u32 s52, s39, 151003136
    buffer_load_dwordx4 v12, s[44:47], s52 offen offset:0 sc1 lds
    buffer_load_dwordx4 v12, s[44:47], s52 offen offset:1024 sc1 lds
    buffer_load_dwordx4 v12, s[44:47], s52 offen offset:2048 sc1 lds
    buffer_load_dwordx4 v12, s[44:47], s52 offen offset:3072 sc1 lds
    s_mov_b32 m0, 8192
    s_add_u32 s52, s59, 151003136
    buffer_load_dwordx4 v12, s[44:47], s52 offen offset:0 sc1 lds
    buffer_load_dwordx4 v12, s[44:47], s52 offen offset:1024 sc1 lds
    buffer_load_dwordx4 v12, s[44:47], s52 offen offset:2048 sc1 lds
    buffer_load_dwordx4 v12, s[44:47], s52 offen offset:3072 sc1 lds
    s_mov_b32 m0, 16384
    s_add_u32 s52, s39, 151011328
    buffer_load_dwordx4 v12, s[44:47], s52 offen offset:0 sc1 lds
    buffer_load_dwordx4 v12, s[44:47], s52 offen offset:1024 sc1 lds
    buffer_load_dwordx4 v12, s[44:47], s52 offen offset:2048 sc1 lds
    buffer_load_dwordx4 v12, s[44:47], s52 offen offset:3072 sc1 lds
L_v3:
    s_waitcnt vmcnt(16)
    ds_read_b128 v[128:131], v13 offset:0
    ds_read_b128 v[132:135], v13 offset:1024
    ds_read_b128 v[136:139], v13 offset:2048
    ds_read_b128 v[140:143], v13 offset:3072
    s_waitcnt vmcnt(12)
    ds_read_b128 v[144:147], v13 offset:8192
    ds_read_b128 v[148:151], v13 offset:9216
    ds_read_b128 v[152:155], v13 offset:10240
    ds_read_b128 v[156:159], v13 offset:11264
    s_waitcnt lgkmcnt(7)
    v_xor_b32 v18, v128, v25
    v_xor_b32 v19, v129, v26
    v_xor_b32 v16, v130, v27
    v_xor_b32 v17, v131, v28
    s_waitcnt lgkmcnt(6)
    v_bitop3_b32 v18, v18, v132, v25 bitop3:0xf6
    v_bitop3_b32 v19, v19, v133, v26 bitop3:0xf6
    v_bitop3_b32 v16, v16, v134, v27 bitop3:0xf6
    v_bitop3_b32 v17, v17, v135, v28 bitop3:0xf6
    s_waitcnt lgkmcnt(5)
    v_bitop3_b32 v18, v18, v136, v25 bitop3:0xf6
    v_bitop3_b32 v19, v19, v137, v26 bitop3:0xf6
    v_bitop3_b32 v16, v16, v138, v27 bitop3:0xf6
    v_bitop3_b32 v17, v17, v139, v28 bitop3:0xf6
    s_waitcnt lgkmcnt(4)
    v_bitop3_b32 v18, v18, v140, v25 bitop3:0xf6
    v_bitop3_b32 v19, v19, v141, v26 bitop3:0xf6
    v_bitop3_b32 v16, v16, v142, v27 bitop3:0xf6
    v_bitop3_b32 v17, v17, v143, v28 bitop3:0xf6
    s_waitcnt lgkmcnt(3)
    v_bitop3_b32 v18, v18, v144, v25 bitop3:0xf6
    v_bitop3_b32 v19, v19, v145, v26 bitop3:0xf6
    v_bitop3_b32 v16, v16, v146, v27 bitop3:0xf6
    v_bitop3_b32 v17, v17, v147, v28 bitop3:0xf6
    s_waitcnt lgkmcnt(2)
    v_bitop3_b32 v18, v18, v148, v25 bitop3:0xf6
    v_bitop3_b32 v19, v19, v149, v26 bitop3:0xf6
    v_bitop3_b32 v16, v16, v150, v27 bitop3:0xf6
    v_bitop3_b32 v17, v17, v151, v28 bitop3:0xf6
    s_waitcnt lgkmcnt(1)
    v_bitop3_b32 v18, v18, v152, v25 bitop3:0xf6
    v_bitop3_b32 v19, v19, v153, v26 bitop3:0xf6
    v_bitop3_b32 v16, v16, v154, v27 bitop3:0xf6
    v_bitop3_b32 v17, v17, v155, v28 bitop3:0xf6
    s_waitcnt lgkmcnt(0)
    v_bitop3_b32 v18, v18, v156, v25 bitop3:0xf6
    v_bitop3_b32 v19, v19, v157, v26 bitop3:0xf6
    v_bitop3_b32 v16, v16, v158, v27 bitop3:0xf6
    v_bitop3_b32 v17, v17, v159, v28 bitop3:0xf6
    v_or3_b32 v16, v16, v17, v18
    v_bitop3_b32 v16, v16, v19, v24 bitop3:0xa8
    v_cmp_ne_u32 vcc, 0, v16
    s_cbranch_vccnz L_vr3
L_vd3:
    v_lshlrev_b32 v72, 16, v66
    v_and_b32 v73, v125, v66
    v_lshlrev_b32 v74, 16, v67
    v_and_b32 v75, v125, v67
    s_barrier
    s_mov_b32 m0, 122880
    s_add_u32 s52, s59, 151011328
    buffer_load_dwordx4 v12, s[44:47], s52 offen offset:0 sc1 lds
    buffer_load_dwordx4 v12, s[44:47], s52 offen offset:1024 sc1 lds
    buffer_load_dwordx4 v12, s[44:47], s52 offen offset:2048 sc1 lds
    buffer_load_dwordx4 v12, s[44:47], s52 offen offset:3072 sc1 lds
L_v4:
    s_waitcnt vmcnt(12)
    ds_read_b128 v[128:131], v13 offset:32768
    ds_read_b128 v[132:135], v13 offset:33792
    ds_read_b128 v[136:139], v13 offset:34816
    ds_read_b128 v[140:143], v13 offset:35840
    s_waitcnt lgkmcnt(3)
    v_xor_b32 v18, v128, v25
    v_xor_b32 v19, v129, v26
    v_xor_b32 v16, v130, v27
    v_xor_b32 v17, v131, v28
    s_waitcnt lgkmcnt(2)
    v_bitop3_b32 v18, v18, v132, v25 bitop3:0xf6
    v_bitop3_b32 v19, v19, v133, v26 bitop3:0xf6
    v_bitop3_b32 v16, v16, v134, v27 bitop3:0xf6
    v_bitop3_b32 v17, v17, v135, v28 bitop3:0xf6
    s_waitcnt lgkmcnt(1)
    v_bitop3_b32 v18, v18, v136, v25 bitop3:0xf6
    v_bitop3_b32 v19, v19, v137, v26 bitop3:0xf6
    v_bitop3_b32 v16, v16, v138, v27 bitop3:0xf6
    v_bitop3_b32 v17, v17, v139, v28 bitop3:0xf6
    s_waitcnt lgkmcnt(0)
    v_bitop3_b32 v18, v18, v140, v25 bitop3:0xf6
    v_bitop3_b32 v19, v19, v141, v26 bitop3:0xf6
    v_bitop3_b32 v16, v16, v142, v27 bitop3:0xf6
    v_bitop3_b32 v17, v17, v143, v28 bitop3:0xf6
    v_or3_b32 v16, v16, v17, v18
    v_bitop3_b32 v16, v16, v19, v24 bitop3:0xa8
    v_cmp_ne_u32 vcc, 0, v16
    s_cbranch_vccnz L_vr4
L_vd4:
    s_barrier
L_v5:
    s_waitcnt vmcnt(8)
    ds_read_b128 v[128:131], v12 offset:8192
    ds_read_b128 v[132:135], v12 offset:9216
    ds_read_b128 v[136:139], v12 offset:10240
    ds_read_b128 v[140:143], v12 offset:11264
    s_waitcnt vmcnt(4)
    ds_read_b128 v[144:147], v12 offset:16384
    ds_read_b128 v[148:151], v12 offset:17408
    ds_read_b128 v[152:155], v12 offset:18432
    ds_read_b128 v[156:159], v12 offset:19456
    s_waitcnt lgkmcnt(7)
    v_xor_b32 v18, v128, v25
    v_xor_b32 v19, v129, v26
    v_xor_b32 v16, v130, v27
    v_xor_b32 v17, v131, v28
    s_waitcnt lgkmcnt(6)
    v_bitop3_b32 v18, v18, v132, v25 bitop3:0xf6
    v_bitop3_b32 v19, v19, v133, v26 bitop3:0xf6
    v_bitop3_b32 v16, v16, v134, v27 bitop3:0xf6
    v_bitop3_b32 v17, v17, v135, v28 bitop3:0xf6
    s_waitcnt lgkmcnt(5)
    v_bitop3_b32 v18, v18, v136, v25 bitop3:0xf6
    v_bitop3_b32 v19, v19, v137, v26 bitop3:0xf6
    v_bitop3_b32 v16, v16, v138, v27 bitop3:0xf6
    v_bitop3_b32 v17, v17, v139, v28 bitop3:0xf6
    s_waitcnt lgkmcnt(4)
    v_bitop3_b32 v18, v18, v140, v25 bitop3:0xf6
    v_bitop3_b32 v19, v19, v141, v26 bitop3:0xf6
    v_bitop3_b32 v16, v16, v142, v27 bitop3:0xf6
    v_bitop3_b32 v17, v17, v143, v28 bitop3:0xf6
    s_waitcnt lgkmcnt(3)
    v_bitop3_b32 v18, v18, v144, v25 bitop3:0xf6
    v_bitop3_b32 v19, v19, v145, v26 bitop3:0xf6
    v_bitop3_b32 v16, v16, v146, v27 bitop3:0xf6
    v_bitop3_b32 v17, v17, v147, v28 bitop3:0xf6
    s_waitcnt lgkmcnt(2)
    v_bitop3_b32 v18, v18, v148, v25 bitop3:0xf6
    v_bitop3_b32 v19, v19, v149, v26 bitop3:0xf6
    v_bitop3_b32 v16, v16, v150, v27 bitop3:0xf6
    v_bitop3_b32 v17, v17, v151, v28 bitop3:0xf6
    s_waitcnt lgkmcnt(1)
    v_bitop3_b32 v18, v18, v152, v25 bitop3:0xf6
    v_bitop3_b32 v19, v19, v153, v26 bitop3:0xf6
    v_bitop3_b32 v16, v16, v154, v27 bitop3:0xf6
    v_bitop3_b32 v17, v17, v155, v28 bitop3:0xf6
    s_waitcnt lgkmcnt(0)
    v_bitop3_b32 v18, v18, v156, v25 bitop3:0xf6
    v_bitop3_b32 v19, v19, v157, v26 bitop3:0xf6
    v_bitop3_b32 v16, v16, v158, v27 bitop3:0xf6
    v_bitop3_b32 v17, v17, v159, v28 bitop3:0xf6
    v_or3_b32 v16, v16, v17, v18
    v_bitop3_b32 v16, v16, v19, v24 bitop3:0xa8
    v_cmp_ne_u32 vcc, 0, v16
    s_cbranch_vccnz L_vr5
L_vd5:
    s_barrier
L_v6:
    s_waitcnt vmcnt(0)
    ds_read_b128 v[128:131], v13 offset:57344
    ds_read_b128 v[132:135], v13 offset:58368
    ds_read_b128 v[136:139], v13 offset:59392
    ds_read_b128 v[140:143], v13 offset:60416
    s_waitcnt lgkmcnt(3)
    v_xor_b32 v18, v128, v25
    v_xor_b32 v19, v129, v26
    v_xor_b32 v16, v130, v27
    v_xor_b32 v17, v131, v28
    s_waitcnt lgkmcnt(2)
    v_bitop3_b32 v18, v18, v132, v25 bitop3:0xf6
    v_bitop3_b32 v19, v19, v133, v26 bitop3:0xf6
    v_bitop3_b32 v16, v16, v134, v27 bitop3:0xf6
    v_bitop3_b32 v17, v17, v135, v28 bitop3:0xf6
    s_waitcnt lgkmcnt(1)
    v_bitop3_b32 v18, v18, v136, v25 bitop3:0xf6
    v_bitop3_b32 v19, v19, v137, v26 bitop3:0xf6
    v_bitop3_b32 v16, v16, v138, v27 bitop3:0xf6
    v_bitop3_b32 v17, v17, v139, v28 bitop3:0xf6
    s_waitcnt lgkmcnt(0)
    v_bitop3_b32 v18, v18, v140, v25 bitop3:0xf6
    v_bitop3_b32 v19, v19, v141, v26 bitop3:0xf6
    v_bitop3_b32 v16, v16, v142, v27 bitop3:0xf6
    v_bitop3_b32 v17, v17, v143, v28 bitop3:0xf6
    v_or3_b32 v16, v16, v17, v18
    v_bitop3_b32 v16, v16, v19, v24 bitop3:0xa8
    v_cmp_ne_u32 vcc, 0, v16
    s_cbranch_vccnz L_vr6
L_vd6:
    s_barrier
    s_barrier
    s_barrier
    s_branch L_reduce
L_vr3:
    s_cmp_gt_u32 s58, 100000
    s_cbranch_scc1 L_vd3
    s_mov_b32 m0, 65536
    s_add_u32 s52, s39, 150994944
    buffer_load_dwordx4 v12, s[44:47], s52 offen offset:0 sc1 lds
    buffer_load_dwordx4 v12, s[44:47], s52 offen offset:1024 sc1 lds
    buffer_load_dwordx4 v12, s[44:47], s52 offen offset:2048 sc1 lds
    buffer_load_dwordx4 v12, s[44:47], s52 offen offset:3072 sc1 lds
    s_mov_b32 m0, 73728
    s_add_u32 s52, s59, 150994944
    buffer_load_dwordx4 v12, s[44:47], s52 offen offset:0 sc1 lds
    buffer_load_dwordx4 v12, s[44:47], s52 offen offset:1024 sc1 lds
    buffer_load_dwordx4 v12, s[44:47], s52 offen offset:2048 sc1 lds
    buffer_load_dwordx4 v12, s[44:47], s52 offen offset:3072 sc1 lds
    s_add_u32 s58, s58, 1
    s_waitcnt vmcnt(0)
    s_branch L_v3
L_vr4:
    s_cmp_gt_u32 s58, 100000
    s_cbranch_scc1 L_vd4
    s_mov_b32 m0, 98304
    s_add_u32 s52, s39, 151003136
    buffer_load_dwordx4 v12, s[44:47], s52 offen offset:0 sc1 lds
    buffer_load_dwordx4 v12, s[44:47], s52 offen offset:1024 sc1 lds
    buffer_load_dwordx4 v12, s[44:47], s52 offen offset:2048 sc1 lds
    buffer_load_dwordx4 v12, s[44:47], s52 offen offset:3072 sc1 lds
    s_add_u32 s58, s58, 1
    s_waitcnt vmcnt(0)
    s_branch L_v4
L_vr5:
    s_cmp_gt_u32 s58, 100000
    s_cbranch_scc1 L_vd5
    s_mov_b32 m0, 8192
    s_add_u32 s52, s59, 151003136
    buffer_load_dwordx4 v12, s[44:47], s52 offen offset:0 sc1 lds
    buffer_load_dwordx4 v12, s[44:47], s52 offen offset:1024 sc1 lds
    buffer_load_dwordx4 v12, s[44:47], s52 offen offset:2048 sc1 lds
    buffer_load_dwordx4 v12, s[44:47], s52 offen offset:3072 sc1 lds
    s_mov_b32 m0, 16384
    s_add_u32 s52, s39, 151011328
    buffer_load_dwordx4 v12, s[44:47], s52 offen offset:0 sc1 lds
    buffer_load_dwordx4 v12, s[44:47], s52 offen offset:1024 sc1 lds
    buffer_load_dwordx4 v12, s[44:47], s52 offen offset:2048 sc1 lds
    buffer_load_dwordx4 v12, s[44:47], s52 offen offset:3072 sc1 lds
    s_add_u32 s58, s58, 1
    s_waitcnt vmcnt(0)
    s_branch L_v5
L_vr6:
    s_cmp_gt_u32 s58, 100000
    s_cbranch_scc1 L_vd6
    s_mov_b32 m0, 122880
    s_add_u32 s52, s59, 151011328
    buffer_load_dwordx4 v12, s[44:47], s52 offen offset:0 sc1 lds
    buffer_load_dwordx4 v12, s[44:47], s52 offen offset:1024 sc1 lds
    buffer_load_dwordx4 v12, s[44:47], s52 offen offset:2048 sc1 lds
    buffer_load_dwordx4 v12, s[44:47], s52 offen offset:3072 sc1 lds
    s_add_u32 s58, s58, 1
    s_waitcnt vmcnt(0)
    s_branch L_v6
L_tail_h2:
    s_setprio 1
    v_lshlrev_b32 v12, 4, v1
    v_add_u32 v13, 0x10000, v12
    v_add_u32 v14, 0x20000, v12
    s_sub_u32 s52, s37, s35
    s_add_u32 s53, s35, 1
    s_cmp_ge_u32 s53, 3
    s_cselect_b32 s54, 3, 0
    s_sub_u32 s53, s53, s54
    s_add_u32 s53, s53, s52
    s_mul_i32 s39, s53, 24576
    s_add_u32 s53, s35, 2
    s_cmp_ge_u32 s53, 3
    s_cselect_b32 s54, 3, 0
    s_sub_u32 s53, s53, s54
    s_add_u32 s53, s53, s52
    s_mul_i32 s59, s53, 24576
    s_mov_b32 s44, s30
    s_mov_b32 s45, s31
    s_mov_b32 s46, 268435456
    s_mov_b32 s47, 0x00020000
    s_lshl_b32 s52, s34, 7
    s_add_u32 s52, s52, 163577856
    s_load_dword s6, s[30:31], s52
    v_lshlrev_b32 v2, 4, v2
    v_add_u32 v2, 65536, v2
    s_waitcnt vmcnt(0)
    v_lshlrev_b32 v6, 16, v4
    v_and_b32 v7, 0xffff0000, v4
    v_lshlrev_b32 v8, 16, v5
    v_and_b32 v9, 0xffff0000, v5
    ds_write_b128 v2, v[6:9] offset:57344
    s_waitcnt lgkmcnt(0)
    s_barrier
    s_barrier
    s_waitcnt lgkmcnt(0)
    s_add_u32 s6, s6, 1
    s_mul_i32 s7, s6, 0x22222222
    s_and_b32 s7, s7, 0xeeeeeeee
    s_or_b32 s7, s7, 0x10101010
    v_and_b32 v16, 3, v1
    v_lshlrev_b32 v16, 3, v16
    v_lshrrev_b32 v16, v16, s7
    v_bfe_u32 v25, v16, 0, 2
    v_mul_u32_u24 v25, 0x8001, v25
    v_and_b32 v25, 0x10001, v25
    v_lshl_or_b32 v25, v25, 15, v25
    v_bfe_u32 v26, v16, 2, 2
    v_mul_u32_u24 v26, 0x8001, v26
    v_and_b32 v26, 0x10001, v26
    v_lshl_or_b32 v26, v26, 15, v26
    v_bfe_u32 v27, v16, 4, 2
    v_mul_u32_u24 v27, 0x8001, v27
    v_and_b32 v27, 0x10001, v27
    v_lshl_or_b32 v27, v27, 15, v27
    v_bfe_u32 v28, v16, 6, 2
    v_mul_u32_u24 v28, 0x8001, v28
    v_and_b32 v28, 0x10001, v28
    v_lshl_or_b32 v28, v28, 15, v28
    v_mov_b32 v24, 65537
    s_mov_b32 s58, 0
    s_barrier
    s_barrier
    s_barrier
    s_barrier
    s_barrier
    s_barrier
    s_barrier
    s_sub_u32 s13, s36, 4
    v_lshlrev_b32 v64, 3, v1
    s_lshl_b32 s61, s13, 6
    s_lshr_b32 s60, s13, 1
    s_mul_i32 s60, s60, 65536
    s_and_b32 s53, s13, 1
    s_lshl_b32 s53, s53, 9
    s_add_u32 s60, s60, s53
    v_lshrrev_b32 v112, 4, v1
    v_and_b32 v113, 1, v1
    v_lshlrev_b32 v113, 3, v113
    v_lshl_add_u32 v112, v112, 4, v113
    v_bfe_u32 v114, v1, 1, 3
    v_and_b32 v115, 7, v1
    v_lshlrev_b32 v115, 2, v115
    s_mul_i32 s53, s35, 384
    s_add_u32 s61, s61, s53
    s_mov_b32 s48, s24
    s_mov_b32 s49, s25
    s_mov_b32 s50, 1152
    s_mov_b32 s51, 0x00020000
    buffer_load_dwordx2 v[66:67], v112, s[48:51], s61 offen
    s_lshl_b32 s53, s32, 3
    s_lshl_b32 s55, s34, 6
    s_add_u32 s53, s53, s55
    s_mul_i32 s53, s53, 1152
    s_add_u32 s61, s61, s53
    v_mul_u32_u24 v114, 1152, v114
    v_add_u32 v65, v112, v114
    s_mul_i32 s53, s33, 196608
    s_add_u32 s60, s60, s53
    s_mul_i32 s53, s32, 8192
    s_add_u32 s60, s60, s53
    s_add_u32 s60, s60, 155713536
    v_mov_b32 v117, 0
    v_lshrrev_b32 v115, v115, s7
    v_bfe_u32 v120, v115, 0, 2
    v_mul_u32_u24 v120, 0x8001, v120
    v_bfe_u32 v121, v115, 2, 2
    v_mul_u32_u24 v121, 0x8001, v121
    v_mov_b32 v124, 0x10001
    v_mov_b32 v125, 0xffff0000
    s_barrier
    s_barrier
    s_barrier
    s_mov_b32 m0, 69632
    s_add_u32 s52, s39, 150999040
    buffer_load_dwordx4 v12, s[44:47], s52 offen offset:0 sc1 lds
    buffer_load_dwordx4 v12, s[44:47], s52 offen offset:1024 sc1 lds
    buffer_load_dwordx4 v12, s[44:47], s52 offen offset:2048 sc1 lds
    buffer_load_dwordx4 v12, s[44:47], s52 offen offset:3072 sc1 lds
    s_mov_b32 m0, 77824
    s_add_u32 s52, s59, 150999040
    buffer_load_dwordx4 v12, s[44:47], s52 offen offset:0 sc1 lds
    buffer_load_dwordx4 v12, s[44:47], s52 offen offset:1024 sc1 lds
    buffer_load_dwordx4 v12, s[44:47], s52 offen offset:2048 sc1 lds
    buffer_load_dwordx4 v12, s[44:47], s52 offen offset:3072 sc1 lds
    s_mov_b32 m0, 102400
    s_add_u32 s52, s39, 151007232
    buffer_load_dwordx4 v12, s[44:47], s52 offen offset:0 sc1 lds
    buffer_load_dwordx4 v12, s[44:47], s52 offen offset:1024 sc1 lds
    buffer_load_dwordx4 v12, s[44:47], s52 offen offset:2048 sc1 lds
    buffer_load_dwordx4 v12, s[44:47], s52 offen offset:3072 sc1 lds
    s_mov_b32 m0, 12288
    s_add_u32 s52, s59, 151007232
    buffer_load_dwordx4 v12, s[44:47], s52 offen offset:0 sc1 lds
    buffer_load_dwordx4 v12, s[44:47], s52 offen offset:1024 sc1 lds
    buffer_load_dwordx4 v12, s[44:47], s52 offen offset:2048 sc1 lds
    buffer_load_dwordx4 v12, s[44:47], s52 offen offset:3072 sc1 lds
    s_mov_b32 m0, 20480
    s_add_u32 s52, s39, 151015424
    buffer_load_dwordx4 v12, s[44:47], s52 offen offset:0 sc1 lds
    buffer_load_dwordx4 v12, s[44:47], s52 offen offset:1024 sc1 lds
    buffer_load_dwordx4 v12, s[44:47], s52 offen offset:2048 sc1 lds
    buffer_load_dwordx4 v12, s[44:47], s52 offen offset:3072 sc1 lds
L_v8:
    s_waitcnt vmcnt(16)
    ds_read_b128 v[128:131], v13 offset:4096
    ds_read_b128 v[132:135], v13 offset:5120
    ds_read_b128 v[136:139], v13 offset:6144
    ds_read_b128 v[140:143], v13 offset:7168
    s_waitcnt vmcnt(12)
    ds_read_b128 v[144:147], v13 offset:12288
    ds_read_b128 v[148:151], v13 offset:13312
    ds_read_b128 v[152:155], v13 offset:14336
    ds_read_b128 v[156:159], v13 offset:15360
    s_waitcnt lgkmcnt(7)
    v_xor_b32 v18, v128, v25
    v_xor_b32 v19, v129, v26
    v_xor_b32 v16, v130, v27
    v_xor_b32 v17, v131, v28
    s_waitcnt lgkmcnt(6)
    v_bitop3_b32 v18, v18, v132, v25 bitop3:0xf6
    v_bitop3_b32 v19, v19, v133, v26 bitop3:0xf6
    v_bitop3_b32 v16, v16, v134, v27 bitop3:0xf6
    v_bitop3_b32 v17, v17, v135, v28 bitop3:0xf6
    s_waitcnt lgkmcnt(5)
    v_bitop3_b32 v18, v18, v136, v25 bitop3:0xf6
    v_bitop3_b32 v19, v19, v137, v26 bitop3:0xf6
    v_bitop3_b32 v16, v16, v138, v27 bitop3:0xf6
    v_bitop3_b32 v17, v17, v139, v28 bitop3:0xf6
    s_waitcnt lgkmcnt(4)
    v_bitop3_b32 v18, v18, v140, v25 bitop3:0xf6
    v_bitop3_b32 v19, v19, v141, v26 bitop3:0xf6
    v_bitop3_b32 v16, v16, v142, v27 bitop3:0xf6
    v_bitop3_b32 v17, v17, v143, v28 bitop3:0xf6
    s_waitcnt lgkmcnt(3)
    v_bitop3_b32 v18, v18, v144, v25 bitop3:0xf6
    v_bitop3_b32 v19, v19, v145, v26 bitop3:0xf6
    v_bitop3_b32 v16, v16, v146, v27 bitop3:0xf6
    v_bitop3_b32 v17, v17, v147, v28 bitop3:0xf6
    s_waitcnt lgkmcnt(2)
    v_bitop3_b32 v18, v18, v148, v25 bitop3:0xf6
    v_bitop3_b32 v19, v19, v149, v26 bitop3:0xf6
    v_bitop3_b32 v16, v16, v150, v27 bitop3:0xf6
    v_bitop3_b32 v17, v17, v151, v28 bitop3:0xf6
    s_waitcnt lgkmcnt(1)
    v_bitop3_b32 v18, v18, v152, v25 bitop3:0xf6
    v_bitop3_b32 v19, v19, v153, v26 bitop3:0xf6
    v_bitop3_b32 v16, v16, v154, v27 bitop3:0xf6
    v_bitop3_b32 v17, v17, v155, v28 bitop3:0xf6
    s_waitcnt lgkmcnt(0)
    v_bitop3_b32 v18, v18, v156, v25 bitop3:0xf6
    v_bitop3_b32 v19, v19, v157, v26 bitop3:0xf6
    v_bitop3_b32 v16, v16, v158, v27 bitop3:0xf6
    v_bitop3_b32 v17, v17, v159, v28 bitop3:0xf6
    v_or3_b32 v16, v16, v17, v18
    v_bitop3_b32 v16, v16, v19, v24 bitop3:0xa8
    v_cmp_ne_u32 vcc, 0, v16
    s_cbranch_vccnz L_vr8
L_vd8:
    v_lshlrev_b32 v72, 16, v66
    v_and_b32 v73, v125, v66
    v_lshlrev_b32 v74, 16, v67
    v_and_b32 v75, v125, v67
    s_barrier
    s_mov_b32 m0, 126976
    s_add_u32 s52, s59, 151015424
    buffer_load_dwordx4 v12, s[44:47], s52 offen offset:0 sc1 lds
    buffer_load_dwordx4 v12, s[44:47], s52 offen offset:1024 sc1 lds
    buffer_load_dwordx4 v12, s[44:47], s52 offen offset:2048 sc1 lds
    buffer_load_dwordx4 v12, s[44:47], s52 offen offset:3072 sc1 lds
L_v9:
    s_waitcnt vmcnt(12)
    ds_read_b128 v[128:131], v13 offset:36864
    ds_read_b128 v[132:135], v13 offset:37888
    ds_read_b128 v[136:139], v13 offset:38912
    ds_read_b128 v[140:143], v13 offset:39936
    s_waitcnt lgkmcnt(3)
    v_xor_b32 v18, v128, v25
    v_xor_b32 v19, v129, v26
    v_xor_b32 v16, v130, v27
    v_xor_b32 v17, v131, v28
    s_waitcnt lgkmcnt(2)
    v_bitop3_b32 v18, v18, v132, v25 bitop3:0xf6
    v_bitop3_b32 v19, v19, v133, v26 bitop3:0xf6
    v_bitop3_b32 v16, v16, v134, v27 bitop3:0xf6
    v_bitop3_b32 v17, v17, v135, v28 bitop3:0xf6
    s_waitcnt lgkmcnt(1)
    v_bitop3_b32 v18, v18, v136, v25 bitop3:0xf6
    v_bitop3_b32 v19, v19, v137, v26 bitop3:0xf6
    v_bitop3_b32 v16, v16, v138, v27 bitop3:0xf6
    v_bitop3_b32 v17, v17, v139, v28 bitop3:0xf6
    s_waitcnt lgkmcnt(0)
    v_bitop3_b32 v18, v18, v140, v25 bitop3:0xf6
    v_bitop3_b32 v19, v19, v141, v26 bitop3:0xf6
    v_bitop3_b32 v16, v16, v142, v27 bitop3:0xf6
    v_bitop3_b32 v17, v17, v143, v28 bitop3:0xf6
    v_or3_b32 v16, v16, v17, v18
    v_bitop3_b32 v16, v16, v19, v24 bitop3:0xa8
    v_cmp_ne_u32 vcc, 0, v16
    s_cbranch_vccnz L_vr9
L_vd9:
    s_barrier
L_v10:
    s_waitcnt vmcnt(8)
    ds_read_b128 v[128:131], v12 offset:12288
    ds_read_b128 v[132:135], v12 offset:13312
    ds_read_b128 v[136:139], v12 offset:14336
    ds_read_b128 v[140:143], v12 offset:15360
    s_waitcnt vmcnt(4)
    ds_read_b128 v[144:147], v12 offset:20480
    ds_read_b128 v[148:151], v12 offset:21504
    ds_read_b128 v[152:155], v12 offset:22528
    ds_read_b128 v[156:159], v12 offset:23552
    s_waitcnt lgkmcnt(7)
    v_xor_b32 v18, v128, v25
    v_xor_b32 v19, v129, v26
    v_xor_b32 v16, v130, v27
    v_xor_b32 v17, v131, v28
    s_waitcnt lgkmcnt(6)
    v_bitop3_b32 v18, v18, v132, v25 bitop3:0xf6
    v_bitop3_b32 v19, v19, v133, v26 bitop3:0xf6
    v_bitop3_b32 v16, v16, v134, v27 bitop3:0xf6
    v_bitop3_b32 v17, v17, v135, v28 bitop3:0xf6
    s_waitcnt lgkmcnt(5)
    v_bitop3_b32 v18, v18, v136, v25 bitop3:0xf6
    v_bitop3_b32 v19, v19, v137, v26 bitop3:0xf6
    v_bitop3_b32 v16, v16, v138, v27 bitop3:0xf6
    v_bitop3_b32 v17, v17, v139, v28 bitop3:0xf6
    s_waitcnt lgkmcnt(4)
    v_bitop3_b32 v18, v18, v140, v25 bitop3:0xf6
    v_bitop3_b32 v19, v19, v141, v26 bitop3:0xf6
    v_bitop3_b32 v16, v16, v142, v27 bitop3:0xf6
    v_bitop3_b32 v17, v17, v143, v28 bitop3:0xf6
    s_waitcnt lgkmcnt(3)
    v_bitop3_b32 v18, v18, v144, v25 bitop3:0xf6
    v_bitop3_b32 v19, v19, v145, v26 bitop3:0xf6
    v_bitop3_b32 v16, v16, v146, v27 bitop3:0xf6
    v_bitop3_b32 v17, v17, v147, v28 bitop3:0xf6
    s_waitcnt lgkmcnt(2)
    v_bitop3_b32 v18, v18, v148, v25 bitop3:0xf6
    v_bitop3_b32 v19, v19, v149, v26 bitop3:0xf6
    v_bitop3_b32 v16, v16, v150, v27 bitop3:0xf6
    v_bitop3_b32 v17, v17, v151, v28 bitop3:0xf6
    s_waitcnt lgkmcnt(1)
    v_bitop3_b32 v18, v18, v152, v25 bitop3:0xf6
    v_bitop3_b32 v19, v19, v153, v26 bitop3:0xf6
    v_bitop3_b32 v16, v16, v154, v27 bitop3:0xf6
    v_bitop3_b32 v17, v17, v155, v28 bitop3:0xf6
    s_waitcnt lgkmcnt(0)
    v_bitop3_b32 v18, v18, v156, v25 bitop3:0xf6
    v_bitop3_b32 v19, v19, v157, v26 bitop3:0xf6
    v_bitop3_b32 v16, v16, v158, v27 bitop3:0xf6
    v_bitop3_b32 v17, v17, v159, v28 bitop3:0xf6
    v_or3_b32 v16, v16, v17, v18
    v_bitop3_b32 v16, v16, v19, v24 bitop3:0xa8
    v_cmp_ne_u32 vcc, 0, v16
    s_cbranch_vccnz L_vr10
L_vd10:
    s_barrier
L_v11:
    s_waitcnt vmcnt(0)
    ds_read_b128 v[128:131], v13 offset:61440
    ds_read_b128 v[132:135], v13 offset:62464
    ds_read_b128 v[136:139], v13 offset:63488
    ds_read_b128 v[140:143], v13 offset:64512
    s_waitcnt lgkmcnt(3)
    v_xor_b32 v18, v128, v25
    v_xor_b32 v19, v129, v26
    v_xor_b32 v16, v130, v27
    v_xor_b32 v17, v131, v28
    s_waitcnt lgkmcnt(2)
    v_bitop3_b32 v18, v18, v132, v25 bitop3:0xf6
    v_bitop3_b32 v19, v19, v133, v26 bitop3:0xf6
    v_bitop3_b32 v16, v16, v134, v27 bitop3:0xf6
    v_bitop3_b32 v17, v17, v135, v28 bitop3:0xf6
    s_waitcnt lgkmcnt(1)
    v_bitop3_b32 v18, v18, v136, v25 bitop3:0xf6
    v_bitop3_b32 v19, v19, v137, v26 bitop3:0xf6
    v_bitop3_b32 v16, v16, v138, v27 bitop3:0xf6
    v_bitop3_b32 v17, v17, v139, v28 bitop3:0xf6
    s_waitcnt lgkmcnt(0)
    v_bitop3_b32 v18, v18, v140, v25 bitop3:0xf6
    v_bitop3_b32 v19, v19, v141, v26 bitop3:0xf6
    v_bitop3_b32 v16, v16, v142, v27 bitop3:0xf6
    v_bitop3_b32 v17, v17, v143, v28 bitop3:0xf6
    v_or3_b32 v16, v16, v17, v18
    v_bitop3_b32 v16, v16, v19, v24 bitop3:0xa8
    v_cmp_ne_u32 vcc, 0, v16
    s_cbranch_vccnz L_vr11
L_vd11:
    s_barrier
    s_barrier
    s_barrier
    s_branch L_reduce
L_vr8:
    s_cmp_gt_u32 s58, 100000
    s_cbranch_scc1 L_vd8
    s_mov_b32 m0, 69632
    s_add_u32 s52, s39, 150999040
    buffer_load_dwordx4 v12, s[44:47], s52 offen offset:0 sc1 lds
    buffer_load_dwordx4 v12, s[44:47], s52 offen offset:1024 sc1 lds
    buffer_load_dwordx4 v12, s[44:47], s52 offen offset:2048 sc1 lds
    buffer_load_dwordx4 v12, s[44:47], s52 offen offset:3072 sc1 lds
    s_mov_b32 m0, 77824
    s_add_u32 s52, s59, 150999040
    buffer_load_dwordx4 v12, s[44:47], s52 offen offset:0 sc1 lds
    buffer_load_dwordx4 v12, s[44:47], s52 offen offset:1024 sc1 lds
    buffer_load_dwordx4 v12, s[44:47], s52 offen offset:2048 sc1 lds
    buffer_load_dwordx4 v12, s[44:47], s52 offen offset:3072 sc1 lds
    s_add_u32 s58, s58, 1
    s_waitcnt vmcnt(0)
    s_branch L_v8
L_vr9:
    s_cmp_gt_u32 s58, 100000
    s_cbranch_scc1 L_vd9
    s_mov_b32 m0, 102400
    s_add_u32 s52, s39, 151007232
    buffer_load_dwordx4 v12, s[44:47], s52 offen offset:0 sc1 lds
    buffer_load_dwordx4 v12, s[44:47], s52 offen offset:1024 sc1 lds
    buffer_load_dwordx4 v12, s[44:47], s52 offen offset:2048 sc1 lds
    buffer_load_dwordx4 v12, s[44:47], s52 offen offset:3072 sc1 lds
    s_add_u32 s58, s58, 1
    s_waitcnt vmcnt(0)
    s_branch L_v9
L_vr10:
    s_cmp_gt_u32 s58, 100000
    s_cbranch_scc1 L_vd10
    s_mov_b32 m0, 12288
    s_add_u32 s52, s59, 151007232
    buffer_load_dwordx4 v12, s[44:47], s52 offen offset:0 sc1 lds
    buffer_load_dwordx4 v12, s[44:47], s52 offen offset:1024 sc1 lds
    buffer_load_dwordx4 v12, s[44:47], s52 offen offset:2048 sc1 lds
    buffer_load_dwordx4 v12, s[44:47], s52 offen offset:3072 sc1 lds
    s_mov_b32 m0, 20480
    s_add_u32 s52, s39, 151015424
    buffer_load_dwordx4 v12, s[44:47], s52 offen offset:0 sc1 lds
    buffer_load_dwordx4 v12, s[44:47], s52 offen offset:1024 sc1 lds
    buffer_load_dwordx4 v12, s[44:47], s52 offen offset:2048 sc1 lds
    buffer_load_dwordx4 v12, s[44:47], s52 offen offset:3072 sc1 lds
    s_add_u32 s58, s58, 1
    s_waitcnt vmcnt(0)
    s_branch L_v10
L_vr11:
    s_cmp_gt_u32 s58, 100000
    s_cbranch_scc1 L_vd11
    s_mov_b32 m0, 126976
    s_add_u32 s52, s59, 151015424
    buffer_load_dwordx4 v12, s[44:47], s52 offen offset:0 sc1 lds
    buffer_load_dwordx4 v12, s[44:47], s52 offen offset:1024 sc1 lds
    buffer_load_dwordx4 v12, s[44:47], s52 offen offset:2048 sc1 lds
    buffer_load_dwordx4 v12, s[44:47], s52 offen offset:3072 sc1 lds
    s_add_u32 s58, s58, 1
    s_waitcnt vmcnt(0)
    s_branch L_v11
    .fill 969, 4, 0xbf800000
L_tail_c:
    s_mov_b32 s48, s24
    s_mov_b32 s49, s25
    s_mov_b32 s50, 1152
    s_mov_b32 s51, 0x00020000
    v_and_b32 v241, 3, v1
    v_lshlrev_b32 v241, 2, v241
    v_lshl_add_u32 v241, v240, 4, v241
    s_mul_i32 s53, s35, 384
    s_lshl_b32 s52, s36, 5
    s_add_u32 s53, s53, s52
    v_add_u32 v248, s53, v241
    s_lshl_b32 s53, s57, 7
    s_add_u32 s53, s53, 65536
    v_and_b32 v247, 48, v1
    v_add_u32 v247, s53, v247
    s_mov_b32 s44, s30
    s_mov_b32 s45, s31
    s_mov_b32 s46, 268435456
    s_mov_b32 s47, 0x00020000
    v_bfe_u32 v241, v1, 2, 2
    v_lshl_add_u32 v242, v240, 2, v241
    v_lshlrev_b32 v242, 7, v242
    v_bfe_u32 v243, v1, 3, 1
    v_xor_b32 v243, s57, v243
    v_lshl_add_u32 v242, v243, 6, v242
    v_bfe_u32 v243, v1, 4, 1
    v_xor_b32 v243, v240, v243
    v_lshl_add_u32 v242, v243, 5, v242
    v_and_b32 v243, 3, v1
    v_lshl_add_u32 v2, v243, 3, v242
    v_add_u32 v3, 0x10000, v2
    v_add_u32 v4, 0x20000, v2
    v_bfe_u32 v241, v1, 2, 3
    v_lshl_add_u32 v241, v240, 4, v241
    v_lshlrev_b32 v241, 7, v241
    v_lshl_add_u32 v241, v243, 3, v241
    v_bfe_u32 v242, v1, 3, 1
    v_xor_b32 v242, s57, v242
    v_lshl_add_u32 v241, v242, 6, v241
    v_bfe_u32 v242, v1, 4, 1
    v_lshl_add_u32 v7, v242, 5, v241
    v_add_u32 v8, 0x10000, v7
    v_xor_b32 v15, 32, v7
    v_xor_b32 v246, 32, v8
    v_and_b32 v241, 15, v1
    v_bfe_u32 v242, v1, 1, 3
    v_lshrrev_b32 v243, 4, v1
    v_xor_b32 v242, v243, v242
    v_lshlrev_b32 v242, 4, v242
    v_lshl_add_u32 v242, v241, 7, v242
    s_lshl_b32 s52, s56, 12
    s_add_u32 s53, s52, 0x20000
    v_add_u32 v5, s53, v242
    v_xor_b32 v6, 64, v5
    v_lshl_add_u32 v9, v1, 4, s52
    v_add_u32 v10, 0x10000, v9
    v_add_u32 v11, 0x20000, v9
    s_lshl_b32 s53, s57, 11
    s_add_u32 s53, s53, s52
    v_lshlrev_b32 v241, 4, v241
    v_lshl_add_u32 v241, v243, 9, v241
    v_add_u32 v12, s53, v241
    v_add_u32 v13, 0x10000, v12
    v_add_u32 v14, 0x20000, v12
    s_mul_i32 s38, s56, 32768
    s_mul_i32 s53, s33, 196608
    s_add_u32 s38, s38, s53
    s_mul_i32 s53, s32, 1024
    s_add_u32 s38, s38, s53
    s_add_u32 s38, s38, 155713536
    s_lshl_b32 s53, s57, 9
    s_add_u32 s38, s38, s53
    v_bfe_u32 v241, v1, 3, 2
    v_mul_u32_u24 v241, 8192, v241
    v_and_b32 v242, 7, v1
    v_lshl_add_u32 v241, v242, 4, v241
    v_lshl_add_u32 v250, v240, 7, v241
    s_mov_b32 s39, 0x80008000
    s_mov_b32 s63, 0x00010001
    s_mov_b32 s59, 0x7fff7fff
    s_mul_i32 s60, s37, 24576
    s_add_u32 s60, s60, 150994944
    s_add_u32 s61, s60, 8192
    s_add_u32 s62, s60, 16384
    s_waitcnt lgkmcnt(0)
    s_add_u32 s6, s6, 1
    s_mul_i32 s7, s6, 0x22222222
    s_and_b32 s7, s7, 0xeeeeeeee
    s_or_b32 s7, s7, 0x10101010
    s_add_u32 s10, s38, 65536
    s_add_u32 s11, s38, 131072
    v_and_b32 v241, 3, v1
    v_lshlrev_b32 v241, 3, v241
    v_lshrrev_b32 v241, v241, s7
    v_bfe_u32 v251, v241, 0, 2
    v_mul_u32_u24 v251, 0x8001, v251
    v_and_b32 v251, 0x10001, v251
    v_lshl_or_b32 v251, v251, 15, v251
    v_bfe_u32 v252, v241, 2, 2
    v_mul_u32_u24 v252, 0x8001, v252
    v_and_b32 v252, 0x10001, v252
    v_lshl_or_b32 v252, v252, 15, v252
    v_bfe_u32 v253, v241, 4, 2
    v_mul_u32_u24 v253, 0x8001, v253
    v_and_b32 v253, 0x10001, v253
    v_lshl_or_b32 v253, v253, 15, v253
    v_bfe_u32 v254, v241, 6, 2
    v_mul_u32_u24 v254, 0x8001, v254
    v_and_b32 v254, 0x10001, v254
    v_lshl_or_b32 v254, v254, 15, v254
    s_barrier
    ds_read_b128 v[16:19], v247 offset:57344
    ds_read_b128 v[24:27], v247 offset:57344
    ds_read_b128 v[96:99], v5 offset:0
    ds_read_b128 v[100:103], v5 offset:2048
    ds_read_b64_tr_b16 v[64:65], v7 offset:0
    ds_read_b64_tr_b16 v[66:67], v7 offset:1024
    ds_read_b128 v[32:35], v247 offset:57600
    ds_read_b128 v[40:43], v247 offset:57600
    ds_read_b64_tr_b16 v[68:69], v7 offset:8192
    ds_read_b64_tr_b16 v[70:71], v7 offset:9216
    ds_read_b128 v[48:51], v247 offset:57856
    ds_read_b128 v[56:59], v247 offset:57856
    ds_read_b64_tr_b16 v[72:73], v7 offset:16384
    ds_read_b64_tr_b16 v[74:75], v7 offset:17408
    ds_read_b128 v[20:23], v247 offset:57408
    s_waitcnt lgkmcnt(13)
    ds_read_b128 v[28:31], v247 offset:57408
    ds_read_b64_tr_b16 v[76:77], v15 offset:0
    s_waitcnt lgkmcnt(13)
    ds_read_b64_tr_b16 v[78:79], v15 offset:1024
    ds_read_b128 v[36:39], v247 offset:57664
    s_waitcnt lgkmcnt(13)
    ds_read_b128 v[44:47], v247 offset:57664
    ds_read_b64_tr_b16 v[80:81], v15 offset:8192
    s_waitcnt lgkmcnt(13)
    ds_read_b64_tr_b16 v[82:83], v15 offset:9216
    ds_read_b128 v[52:55], v247 offset:57920
    s_waitcnt lgkmcnt(13)
    ds_read_b128 v[60:63], v247 offset:57920
    ds_read_b64_tr_b16 v[84:85], v15 offset:16384
    s_waitcnt lgkmcnt(13)
    ds_read_b64_tr_b16 v[86:87], v15 offset:17408
    v_mfma_f32_16x16x32_bf16 v[16:19], v[64:67], v[96:99], v[16:19]
    v_mfma_f32_16x16x32_bf16 v[24:27], v[64:67], v[100:103], v[24:27]
    ds_read_b128 v[104:107], v6 offset:0
    s_waitcnt lgkmcnt(13)
    ds_read_b128 v[108:111], v6 offset:2048
    ds_read_b64_tr_b16 v[64:65], v7 offset:4096
    s_waitcnt lgkmcnt(13)
    ds_read_b64_tr_b16 v[66:67], v7 offset:5120
    v_mfma_f32_16x16x32_bf16 v[40:43], v[68:71], v[100:103], v[40:43]
    v_mfma_f32_16x16x32_bf16 v[32:35], v[68:71], v[96:99], v[32:35]
    ds_read_b64_tr_b16 v[68:69], v7 offset:12288
    s_waitcnt lgkmcnt(13)
    ds_read_b64_tr_b16 v[70:71], v7 offset:13312
    v_mfma_f32_16x16x32_bf16 v[48:51], v[72:75], v[96:99], v[48:51]
    v_mfma_f32_16x16x32_bf16 v[56:59], v[72:75], v[100:103], v[56:59]
    ds_read_b64_tr_b16 v[72:73], v7 offset:20480
    s_waitcnt lgkmcnt(13)
    ds_read_b64_tr_b16 v[74:75], v7 offset:21504
    v_mfma_f32_16x16x32_bf16 v[28:31], v[76:79], v[100:103], v[28:31]
    v_mfma_f32_16x16x32_bf16 v[20:23], v[76:79], v[96:99], v[20:23]
    ds_read_b64_tr_b16 v[76:77], v15 offset:4096
    s_waitcnt lgkmcnt(13)
    ds_read_b64_tr_b16 v[78:79], v15 offset:5120
    v_mfma_f32_16x16x32_bf16 v[36:39], v[80:83], v[96:99], v[36:39]
    v_mfma_f32_16x16x32_bf16 v[44:47], v[80:83], v[100:103], v[44:47]
    ds_read_b64_tr_b16 v[80:81], v15 offset:12288
    s_waitcnt lgkmcnt(13)
    ds_read_b64_tr_b16 v[82:83], v15 offset:13312
    s_waitcnt lgkmcnt(12)
    v_mfma_f32_16x16x32_bf16 v[60:63], v[84:87], v[100:103], v[60:63]
    v_mfma_f32_16x16x32_bf16 v[52:55], v[84:87], v[96:99], v[52:55]
    ds_read_b64_tr_b16 v[84:85], v15 offset:20480
    ds_read_b64_tr_b16 v[86:87], v15 offset:21504
    s_waitcnt lgkmcnt(10)
    v_mfma_f32_16x16x32_bf16 v[16:19], v[64:67], v[104:107], v[16:19]
    v_mfma_f32_16x16x32_bf16 v[24:27], v[64:67], v[108:111], v[24:27]
    s_barrier
    ds_read_b128 v[112:115], v5 offset:8192
    ds_read_b128 v[116:119], v5 offset:10240
    ds_read_b64_tr_b16 v[64:65], v7 offset:24576
    ds_read_b64_tr_b16 v[66:67], v7 offset:25600
    s_waitcnt lgkmcnt(12)
    v_mfma_f32_16x16x32_bf16 v[40:43], v[68:71], v[108:111], v[40:43]
    v_mfma_f32_16x16x32_bf16 v[32:35], v[68:71], v[104:107], v[32:35]
    ds_read_b64_tr_b16 v[68:69], v7 offset:32768
    ds_read_b64_tr_b16 v[70:71], v7 offset:33792
    s_waitcnt lgkmcnt(12)
    v_mfma_f32_16x16x32_bf16 v[48:51], v[72:75], v[104:107], v[48:51]
    v_mfma_f32_16x16x32_bf16 v[56:59], v[72:75], v[108:111], v[56:59]
    ds_read_b64_tr_b16 v[72:73], v7 offset:40960
    ds_read_b64_tr_b16 v[74:75], v7 offset:41984
    s_waitcnt lgkmcnt(12)
    v_mfma_f32_16x16x32_bf16 v[28:31], v[76:79], v[108:111], v[28:31]
    v_mfma_f32_16x16x32_bf16 v[20:23], v[76:79], v[104:107], v[20:23]
    ds_read_b64_tr_b16 v[76:77], v15 offset:24576
    ds_read_b64_tr_b16 v[78:79], v15 offset:25600
    s_waitcnt lgkmcnt(12)
    v_mfma_f32_16x16x32_bf16 v[36:39], v[80:83], v[104:107], v[36:39]
    v_mfma_f32_16x16x32_bf16 v[44:47], v[80:83], v[108:111], v[44:47]
    ds_read_b64_tr_b16 v[80:81], v15 offset:32768
    ds_read_b64_tr_b16 v[82:83], v15 offset:33792
    s_waitcnt lgkmcnt(12)
    v_mfma_f32_16x16x32_bf16 v[60:63], v[84:87], v[108:111], v[60:63]
    v_mfma_f32_16x16x32_bf16 v[52:55], v[84:87], v[104:107], v[52:55]
    ds_read_b64_tr_b16 v[84:85], v15 offset:40960
    ds_read_b64_tr_b16 v[86:87], v15 offset:41984
    s_waitcnt lgkmcnt(10)
    v_mfma_f32_16x16x32_bf16 v[16:19], v[64:67], v[112:115], v[16:19]
    v_mfma_f32_16x16x32_bf16 v[24:27], v[64:67], v[116:119], v[24:27]
    ds_read_b128 v[120:123], v6 offset:8192
    ds_read_b128 v[124:127], v6 offset:10240
    ds_read_b64_tr_b16 v[64:65], v7 offset:28672
    ds_read_b64_tr_b16 v[66:67], v7 offset:29696
    s_waitcnt lgkmcnt(12)
    v_mfma_f32_16x16x32_bf16 v[40:43], v[68:71], v[116:119], v[40:43]
    v_mfma_f32_16x16x32_bf16 v[32:35], v[68:71], v[112:115], v[32:35]
    ds_read_b64_tr_b16 v[68:69], v7 offset:36864
    ds_read_b64_tr_b16 v[70:71], v7 offset:37888
    s_waitcnt lgkmcnt(12)
    v_mfma_f32_16x16x32_bf16 v[48:51], v[72:75], v[112:115], v[48:51]
    v_mfma_f32_16x16x32_bf16 v[56:59], v[72:75], v[116:119], v[56:59]
    ds_read_b64_tr_b16 v[72:73], v7 offset:45056
    ds_read_b64_tr_b16 v[74:75], v7 offset:46080
    s_waitcnt lgkmcnt(12)
    v_mfma_f32_16x16x32_bf16 v[28:31], v[76:79], v[116:119], v[28:31]
    v_mfma_f32_16x16x32_bf16 v[20:23], v[76:79], v[112:115], v[20:23]
    ds_read_b64_tr_b16 v[76:77], v15 offset:28672
    ds_read_b64_tr_b16 v[78:79], v15 offset:29696
    s_waitcnt lgkmcnt(12)
    v_mfma_f32_16x16x32_bf16 v[36:39], v[80:83], v[112:115], v[36:39]
    v_mfma_f32_16x16x32_bf16 v[44:47], v[80:83], v[116:119], v[44:47]
    ds_read_b64_tr_b16 v[80:81], v15 offset:36864
    ds_read_b64_tr_b16 v[82:83], v15 offset:37888
    s_waitcnt lgkmcnt(12)
    v_mfma_f32_16x16x32_bf16 v[60:63], v[84:87], v[116:119], v[60:63]
    v_mfma_f32_16x16x32_bf16 v[52:55], v[84:87], v[112:115], v[52:55]
    ds_read_b64_tr_b16 v[84:85], v15 offset:45056
    ds_read_b64_tr_b16 v[86:87], v15 offset:46080
    s_waitcnt lgkmcnt(10)
    v_mfma_f32_16x16x32_bf16 v[16:19], v[64:67], v[120:123], v[16:19]
    v_mfma_f32_16x16x32_bf16 v[24:27], v[64:67], v[124:127], v[24:27]
    s_barrier
    ds_read_b128 v[128:131], v5 offset:16384
    ds_read_b128 v[132:135], v5 offset:18432
    ds_read_b64_tr_b16 v[64:65], v7 offset:49152
    ds_read_b64_tr_b16 v[66:67], v7 offset:50176
    s_waitcnt lgkmcnt(12)
    v_mfma_f32_16x16x32_bf16 v[40:43], v[68:71], v[124:127], v[40:43]
    v_mfma_f32_16x16x32_bf16 v[32:35], v[68:71], v[120:123], v[32:35]
    ds_read_b64_tr_b16 v[68:69], v7 offset:57344
    ds_read_b64_tr_b16 v[70:71], v7 offset:58368
    s_waitcnt lgkmcnt(12)
    v_mfma_f32_16x16x32_bf16 v[48:51], v[72:75], v[120:123], v[48:51]
    v_mfma_f32_16x16x32_bf16 v[56:59], v[72:75], v[124:127], v[56:59]
    ds_read_b64_tr_b16 v[72:73], v8 offset:0
    ds_read_b64_tr_b16 v[74:75], v8 offset:1024
    s_waitcnt lgkmcnt(12)
    v_mfma_f32_16x16x32_bf16 v[28:31], v[76:79], v[124:127], v[28:31]
    v_mfma_f32_16x16x32_bf16 v[20:23], v[76:79], v[120:123], v[20:23]
    ds_read_b64_tr_b16 v[76:77], v15 offset:49152
    ds_read_b64_tr_b16 v[78:79], v15 offset:50176
    s_waitcnt lgkmcnt(12)
    v_mfma_f32_16x16x32_bf16 v[36:39], v[80:83], v[120:123], v[36:39]
    v_mfma_f32_16x16x32_bf16 v[44:47], v[80:83], v[124:127], v[44:47]
    ds_read_b64_tr_b16 v[80:81], v15 offset:57344
    ds_read_b64_tr_b16 v[82:83], v15 offset:58368
    s_waitcnt lgkmcnt(12)
    v_mfma_f32_16x16x32_bf16 v[60:63], v[84:87], v[124:127], v[60:63]
    v_mfma_f32_16x16x32_bf16 v[52:55], v[84:87], v[120:123], v[52:55]
    ds_read_b64_tr_b16 v[84:85], v246 offset:0
    ds_read_b64_tr_b16 v[86:87], v246 offset:1024
    s_waitcnt lgkmcnt(10)
    v_mfma_f32_16x16x32_bf16 v[16:19], v[64:67], v[128:131], v[16:19]
    v_mfma_f32_16x16x32_bf16 v[24:27], v[64:67], v[132:135], v[24:27]
    ds_read_b128 v[136:139], v6 offset:16384
    ds_read_b128 v[140:143], v6 offset:18432
    ds_read_b64_tr_b16 v[64:65], v7 offset:53248
    ds_read_b64_tr_b16 v[66:67], v7 offset:54272
    s_waitcnt lgkmcnt(12)
    v_mfma_f32_16x16x32_bf16 v[40:43], v[68:71], v[132:135], v[40:43]
    v_mfma_f32_16x16x32_bf16 v[32:35], v[68:71], v[128:131], v[32:35]
    ds_read_b64_tr_b16 v[68:69], v7 offset:61440
    ds_read_b64_tr_b16 v[70:71], v7 offset:62464
    s_waitcnt lgkmcnt(12)
    v_mfma_f32_16x16x32_bf16 v[48:51], v[72:75], v[128:131], v[48:51]
    v_mfma_f32_16x16x32_bf16 v[56:59], v[72:75], v[132:135], v[56:59]
    ds_read_b64_tr_b16 v[72:73], v8 offset:4096
    ds_read_b64_tr_b16 v[74:75], v8 offset:5120
    s_waitcnt lgkmcnt(12)
    v_mfma_f32_16x16x32_bf16 v[28:31], v[76:79], v[132:135], v[28:31]
    v_mfma_f32_16x16x32_bf16 v[20:23], v[76:79], v[128:131], v[20:23]
    ds_read_b64_tr_b16 v[76:77], v15 offset:53248
    ds_read_b64_tr_b16 v[78:79], v15 offset:54272
    s_waitcnt lgkmcnt(12)
    v_mfma_f32_16x16x32_bf16 v[36:39], v[80:83], v[128:131], v[36:39]
    v_mfma_f32_16x16x32_bf16 v[44:47], v[80:83], v[132:135], v[44:47]
    ds_read_b64_tr_b16 v[80:81], v15 offset:61440
    ds_read_b64_tr_b16 v[82:83], v15 offset:62464
    s_waitcnt lgkmcnt(12)
    v_mfma_f32_16x16x32_bf16 v[60:63], v[84:87], v[132:135], v[60:63]
    v_mfma_f32_16x16x32_bf16 v[52:55], v[84:87], v[128:131], v[52:55]
    ds_read_b64_tr_b16 v[84:85], v246 offset:4096
    ds_read_b64_tr_b16 v[86:87], v246 offset:5120
    s_waitcnt lgkmcnt(10)
    v_mfma_f32_16x16x32_bf16 v[16:19], v[64:67], v[136:139], v[16:19]
    v_mfma_f32_16x16x32_bf16 v[24:27], v[64:67], v[140:143], v[24:27]
    s_barrier
    ds_read_b128 v[144:147], v5 offset:24576
    ds_read_b128 v[148:151], v5 offset:26624
    ds_read_b64_tr_b16 v[64:65], v8 offset:8192
    ds_read_b64_tr_b16 v[66:67], v8 offset:9216
    s_waitcnt lgkmcnt(12)
    v_mfma_f32_16x16x32_bf16 v[40:43], v[68:71], v[140:143], v[40:43]
    v_mfma_f32_16x16x32_bf16 v[32:35], v[68:71], v[136:139], v[32:35]
    ds_read_b64_tr_b16 v[68:69], v8 offset:16384
    ds_read_b64_tr_b16 v[70:71], v8 offset:17408
    s_waitcnt lgkmcnt(12)
    v_mfma_f32_16x16x32_bf16 v[48:51], v[72:75], v[136:139], v[48:51]
    v_mfma_f32_16x16x32_bf16 v[56:59], v[72:75], v[140:143], v[56:59]
    ds_read_b64_tr_b16 v[72:73], v8 offset:24576
    ds_read_b64_tr_b16 v[74:75], v8 offset:25600
    s_waitcnt lgkmcnt(12)
    v_mfma_f32_16x16x32_bf16 v[28:31], v[76:79], v[140:143], v[28:31]
    v_mfma_f32_16x16x32_bf16 v[20:23], v[76:79], v[136:139], v[20:23]
    ds_read_b64_tr_b16 v[76:77], v246 offset:8192
    ds_read_b64_tr_b16 v[78:79], v246 offset:9216
    s_waitcnt lgkmcnt(12)
    v_mfma_f32_16x16x32_bf16 v[36:39], v[80:83], v[136:139], v[36:39]
    v_mfma_f32_16x16x32_bf16 v[44:47], v[80:83], v[140:143], v[44:47]
    ds_read_b64_tr_b16 v[80:81], v246 offset:16384
    ds_read_b64_tr_b16 v[82:83], v246 offset:17408
    s_waitcnt lgkmcnt(12)
    v_mfma_f32_16x16x32_bf16 v[60:63], v[84:87], v[140:143], v[60:63]
    v_mfma_f32_16x16x32_bf16 v[52:55], v[84:87], v[136:139], v[52:55]
    ds_read_b64_tr_b16 v[84:85], v246 offset:24576
    ds_read_b64_tr_b16 v[86:87], v246 offset:25600
    s_waitcnt lgkmcnt(10)
    v_mfma_f32_16x16x32_bf16 v[16:19], v[64:67], v[144:147], v[16:19]
    v_mfma_f32_16x16x32_bf16 v[24:27], v[64:67], v[148:151], v[24:27]
    ds_read_b128 v[152:155], v6 offset:24576
    ds_read_b128 v[156:159], v6 offset:26624
    ds_read_b64_tr_b16 v[64:65], v8 offset:12288
    ds_read_b64_tr_b16 v[66:67], v8 offset:13312
    s_waitcnt lgkmcnt(12)
    v_mfma_f32_16x16x32_bf16 v[40:43], v[68:71], v[148:151], v[40:43]
    v_mfma_f32_16x16x32_bf16 v[32:35], v[68:71], v[144:147], v[32:35]
    ds_read_b64_tr_b16 v[68:69], v8 offset:20480
    ds_read_b64_tr_b16 v[70:71], v8 offset:21504
    s_waitcnt lgkmcnt(12)
    v_mfma_f32_16x16x32_bf16 v[48:51], v[72:75], v[144:147], v[48:51]
    v_mfma_f32_16x16x32_bf16 v[56:59], v[72:75], v[148:151], v[56:59]
    ds_read_b64_tr_b16 v[72:73], v8 offset:28672
    ds_read_b64_tr_b16 v[74:75], v8 offset:29696
    s_waitcnt lgkmcnt(12)
    v_mfma_f32_16x16x32_bf16 v[28:31], v[76:79], v[148:151], v[28:31]
    v_mfma_f32_16x16x32_bf16 v[20:23], v[76:79], v[144:147], v[20:23]
    ds_read_b64_tr_b16 v[76:77], v246 offset:12288
    ds_read_b64_tr_b16 v[78:79], v246 offset:13312
    s_waitcnt lgkmcnt(12)
    v_mfma_f32_16x16x32_bf16 v[36:39], v[80:83], v[144:147], v[36:39]
    v_mfma_f32_16x16x32_bf16 v[44:47], v[80:83], v[148:151], v[44:47]
    ds_read_b64_tr_b16 v[80:81], v246 offset:20480
    ds_read_b64_tr_b16 v[82:83], v246 offset:21504
    s_waitcnt lgkmcnt(12)
    v_mfma_f32_16x16x32_bf16 v[60:63], v[84:87], v[148:151], v[60:63]
    v_mfma_f32_16x16x32_bf16 v[52:55], v[84:87], v[144:147], v[52:55]
    ds_read_b64_tr_b16 v[84:85], v246 offset:28672
    ds_read_b64_tr_b16 v[86:87], v246 offset:29696
    s_waitcnt lgkmcnt(10)
    v_mfma_f32_16x16x32_bf16 v[16:19], v[64:67], v[152:155], v[16:19]
    v_mfma_f32_16x16x32_bf16 v[24:27], v[64:67], v[156:159], v[24:27]
    s_barrier
    ds_read_b128 v[160:163], v5 offset:0
    ds_read_b128 v[164:167], v5 offset:2048
    ds_read_b64_tr_b16 v[64:65], v8 offset:32768
    ds_read_b64_tr_b16 v[66:67], v8 offset:33792
    s_waitcnt lgkmcnt(12)
    v_mfma_f32_16x16x32_bf16 v[40:43], v[68:71], v[156:159], v[40:43]
    v_mfma_f32_16x16x32_bf16 v[32:35], v[68:71], v[152:155], v[32:35]
    ds_read_b64_tr_b16 v[68:69], v8 offset:40960
    ds_read_b64_tr_b16 v[70:71], v8 offset:41984
    s_waitcnt lgkmcnt(12)
    v_mfma_f32_16x16x32_bf16 v[48:51], v[72:75], v[152:155], v[48:51]
    v_mfma_f32_16x16x32_bf16 v[56:59], v[72:75], v[156:159], v[56:59]
    ds_read_b64_tr_b16 v[72:73], v8 offset:49152
    ds_read_b64_tr_b16 v[74:75], v8 offset:50176
    s_waitcnt lgkmcnt(12)
    v_mfma_f32_16x16x32_bf16 v[28:31], v[76:79], v[156:159], v[28:31]
    v_mfma_f32_16x16x32_bf16 v[20:23], v[76:79], v[152:155], v[20:23]
    ds_read_b64_tr_b16 v[76:77], v246 offset:32768
    ds_read_b64_tr_b16 v[78:79], v246 offset:33792
    s_waitcnt lgkmcnt(12)
    v_mfma_f32_16x16x32_bf16 v[36:39], v[80:83], v[152:155], v[36:39]
    v_mfma_f32_16x16x32_bf16 v[44:47], v[80:83], v[156:159], v[44:47]
    ds_read_b64_tr_b16 v[80:81], v246 offset:40960
    ds_read_b64_tr_b16 v[82:83], v246 offset:41984
    s_waitcnt lgkmcnt(12)
    v_mfma_f32_16x16x32_bf16 v[60:63], v[84:87], v[156:159], v[60:63]
    v_mfma_f32_16x16x32_bf16 v[52:55], v[84:87], v[152:155], v[52:55]
    ds_read_b64_tr_b16 v[84:85], v246 offset:49152
    ds_read_b64_tr_b16 v[86:87], v246 offset:50176
    s_waitcnt lgkmcnt(10)
    v_mfma_f32_16x16x32_bf16 v[16:19], v[64:67], v[160:163], v[16:19]
    v_mfma_f32_16x16x32_bf16 v[24:27], v[64:67], v[164:167], v[24:27]
    ds_read_b128 v[168:171], v6 offset:0
    ds_read_b128 v[172:175], v6 offset:2048
    ds_read_b64_tr_b16 v[64:65], v8 offset:36864
    ds_read_b64_tr_b16 v[66:67], v8 offset:37888
    s_waitcnt lgkmcnt(12)
    v_mfma_f32_16x16x32_bf16 v[40:43], v[68:71], v[164:167], v[40:43]
    v_mfma_f32_16x16x32_bf16 v[32:35], v[68:71], v[160:163], v[32:35]
    ds_read_b64_tr_b16 v[68:69], v8 offset:45056
    ds_read_b64_tr_b16 v[70:71], v8 offset:46080
    s_waitcnt lgkmcnt(12)
    v_mfma_f32_16x16x32_bf16 v[48:51], v[72:75], v[160:163], v[48:51]
    v_mfma_f32_16x16x32_bf16 v[56:59], v[72:75], v[164:167], v[56:59]
    ds_read_b64_tr_b16 v[72:73], v8 offset:53248
    ds_read_b64_tr_b16 v[74:75], v8 offset:54272
    s_waitcnt lgkmcnt(12)
    v_mfma_f32_16x16x32_bf16 v[28:31], v[76:79], v[164:167], v[28:31]
    v_mfma_f32_16x16x32_bf16 v[20:23], v[76:79], v[160:163], v[20:23]
    ds_read_b64_tr_b16 v[76:77], v246 offset:36864
    ds_read_b64_tr_b16 v[78:79], v246 offset:37888
    s_waitcnt lgkmcnt(12)
    v_mfma_f32_16x16x32_bf16 v[36:39], v[80:83], v[160:163], v[36:39]
    v_mfma_f32_16x16x32_bf16 v[44:47], v[80:83], v[164:167], v[44:47]
    ds_read_b64_tr_b16 v[80:81], v246 offset:45056
    ds_read_b64_tr_b16 v[82:83], v246 offset:46080
    s_waitcnt lgkmcnt(12)
    v_mfma_f32_16x16x32_bf16 v[60:63], v[84:87], v[164:167], v[60:63]
    v_mfma_f32_16x16x32_bf16 v[52:55], v[84:87], v[160:163], v[52:55]
    ds_read_b64_tr_b16 v[84:85], v246 offset:53248
    ds_read_b64_tr_b16 v[86:87], v246 offset:54272
    s_waitcnt lgkmcnt(10)
    v_mfma_f32_16x16x32_bf16 v[16:19], v[64:67], v[168:171], v[16:19]
    v_mfma_f32_16x16x32_bf16 v[24:27], v[64:67], v[172:175], v[24:27]
    s_barrier
    ds_read_b128 v[176:179], v5 offset:8192
    ds_read_b128 v[180:183], v5 offset:10240
    ds_read_b64_tr_b16 v[64:65], v8 offset:57344
    ds_read_b64_tr_b16 v[66:67], v8 offset:58368
    s_waitcnt lgkmcnt(12)
    v_mfma_f32_16x16x32_bf16 v[40:43], v[68:71], v[172:175], v[40:43]
    v_mfma_f32_16x16x32_bf16 v[32:35], v[68:71], v[168:171], v[32:35]
    ds_read_b64_tr_b16 v[68:69], v7 offset:0
    ds_read_b64_tr_b16 v[70:71], v7 offset:1024
    s_waitcnt lgkmcnt(12)
    v_mfma_f32_16x16x32_bf16 v[48:51], v[72:75], v[168:171], v[48:51]
    v_mfma_f32_16x16x32_bf16 v[56:59], v[72:75], v[172:175], v[56:59]
    ds_read_b64_tr_b16 v[72:73], v7 offset:8192
    ds_read_b64_tr_b16 v[74:75], v7 offset:9216
    s_waitcnt lgkmcnt(12)
    v_mfma_f32_16x16x32_bf16 v[28:31], v[76:79], v[172:175], v[28:31]
    v_mfma_f32_16x16x32_bf16 v[20:23], v[76:79], v[168:171], v[20:23]
    ds_read_b64_tr_b16 v[76:77], v246 offset:57344
    ds_read_b64_tr_b16 v[78:79], v246 offset:58368
    s_waitcnt lgkmcnt(12)
    v_mfma_f32_16x16x32_bf16 v[36:39], v[80:83], v[168:171], v[36:39]
    v_mfma_f32_16x16x32_bf16 v[44:47], v[80:83], v[172:175], v[44:47]
    ds_read_b64_tr_b16 v[80:81], v15 offset:0
    ds_read_b64_tr_b16 v[82:83], v15 offset:1024
    s_waitcnt lgkmcnt(12)
    v_mfma_f32_16x16x32_bf16 v[60:63], v[84:87], v[172:175], v[60:63]
    v_mfma_f32_16x16x32_bf16 v[52:55], v[84:87], v[168:171], v[52:55]
    ds_read_b64_tr_b16 v[84:85], v15 offset:8192
    ds_read_b64_tr_b16 v[86:87], v15 offset:9216
    s_waitcnt lgkmcnt(10)
    v_mfma_f32_16x16x32_bf16 v[16:19], v[64:67], v[176:179], v[16:19]
    v_mfma_f32_16x16x32_bf16 v[24:27], v[64:67], v[180:183], v[24:27]
    ds_read_b128 v[184:187], v6 offset:8192
    ds_read_b128 v[188:191], v6 offset:10240
    ds_read_b64_tr_b16 v[64:65], v8 offset:61440
    ds_read_b64_tr_b16 v[66:67], v8 offset:62464
    s_waitcnt lgkmcnt(12)
    v_mfma_f32_16x16x32_bf16 v[40:43], v[68:71], v[180:183], v[40:43]
    v_mfma_f32_16x16x32_bf16 v[32:35], v[68:71], v[176:179], v[32:35]
    ds_read_b64_tr_b16 v[68:69], v7 offset:4096
    ds_read_b64_tr_b16 v[70:71], v7 offset:5120
    s_waitcnt lgkmcnt(12)
    v_mfma_f32_16x16x32_bf16 v[48:51], v[72:75], v[176:179], v[48:51]
    v_mfma_f32_16x16x32_bf16 v[56:59], v[72:75], v[180:183], v[56:59]
    ds_read_b64_tr_b16 v[72:73], v7 offset:12288
    ds_read_b64_tr_b16 v[74:75], v7 offset:13312
    s_waitcnt lgkmcnt(12)
    v_mfma_f32_16x16x32_bf16 v[28:31], v[76:79], v[180:183], v[28:31]
    v_mfma_f32_16x16x32_bf16 v[20:23], v[76:79], v[176:179], v[20:23]
    ds_read_b64_tr_b16 v[76:77], v246 offset:61440
    ds_read_b64_tr_b16 v[78:79], v246 offset:62464
    s_waitcnt lgkmcnt(12)
    v_mfma_f32_16x16x32_bf16 v[36:39], v[80:83], v[176:179], v[36:39]
    v_mfma_f32_16x16x32_bf16 v[44:47], v[80:83], v[180:183], v[44:47]
    ds_read_b64_tr_b16 v[80:81], v15 offset:4096
    ds_read_b64_tr_b16 v[82:83], v15 offset:5120
    s_waitcnt lgkmcnt(12)
    v_mfma_f32_16x16x32_bf16 v[60:63], v[84:87], v[180:183], v[60:63]
    v_mfma_f32_16x16x32_bf16 v[52:55], v[84:87], v[176:179], v[52:55]
    ds_read_b64_tr_b16 v[84:85], v15 offset:12288
    ds_read_b64_tr_b16 v[86:87], v15 offset:13312
    s_waitcnt lgkmcnt(10)
    v_mfma_f32_16x16x32_bf16 v[16:19], v[64:67], v[184:187], v[16:19]
    v_mfma_f32_16x16x32_bf16 v[24:27], v[64:67], v[188:191], v[24:27]
    s_barrier
    ds_read_b128 v[192:195], v5 offset:16384
    ds_read_b128 v[196:199], v5 offset:18432
    ds_read_b64_tr_b16 v[64:65], v7 offset:40960
    ds_read_b64_tr_b16 v[66:67], v7 offset:41984
    s_waitcnt lgkmcnt(12)
    v_mfma_f32_16x16x32_bf16 v[40:43], v[68:71], v[188:191], v[40:43]
    v_mfma_f32_16x16x32_bf16 v[32:35], v[68:71], v[184:187], v[32:35]
    ds_read_b64_tr_b16 v[68:69], v7 offset:49152
    ds_read_b64_tr_b16 v[70:71], v7 offset:50176
    s_waitcnt lgkmcnt(12)
    v_mfma_f32_16x16x32_bf16 v[48:51], v[72:75], v[184:187], v[48:51]
    v_mfma_f32_16x16x32_bf16 v[56:59], v[72:75], v[188:191], v[56:59]
    ds_read_b64_tr_b16 v[72:73], v7 offset:57344
    ds_read_b64_tr_b16 v[74:75], v7 offset:58368
    s_waitcnt lgkmcnt(12)
    v_mfma_f32_16x16x32_bf16 v[28:31], v[76:79], v[188:191], v[28:31]
    v_mfma_f32_16x16x32_bf16 v[20:23], v[76:79], v[184:187], v[20:23]
    ds_read_b64_tr_b16 v[76:77], v15 offset:40960
    ds_read_b64_tr_b16 v[78:79], v15 offset:41984
    s_waitcnt lgkmcnt(12)
    v_mfma_f32_16x16x32_bf16 v[36:39], v[80:83], v[184:187], v[36:39]
    v_mfma_f32_16x16x32_bf16 v[44:47], v[80:83], v[188:191], v[44:47]
    ds_read_b64_tr_b16 v[80:81], v15 offset:49152
    ds_read_b64_tr_b16 v[82:83], v15 offset:50176
    s_waitcnt lgkmcnt(12)
    v_mfma_f32_16x16x32_bf16 v[60:63], v[84:87], v[188:191], v[60:63]
    v_mfma_f32_16x16x32_bf16 v[52:55], v[84:87], v[184:187], v[52:55]
    ds_read_b64_tr_b16 v[84:85], v15 offset:57344
    ds_read_b64_tr_b16 v[86:87], v15 offset:58368
    s_waitcnt lgkmcnt(10)
    v_mfma_f32_16x16x32_bf16 v[16:19], v[64:67], v[192:195], v[16:19]
    v_mfma_f32_16x16x32_bf16 v[24:27], v[64:67], v[196:199], v[24:27]
    ds_read_b128 v[200:203], v6 offset:16384
    ds_read_b128 v[204:207], v6 offset:18432
    ds_read_b64_tr_b16 v[64:65], v7 offset:45056
    ds_read_b64_tr_b16 v[66:67], v7 offset:46080
    s_waitcnt lgkmcnt(12)
    v_mfma_f32_16x16x32_bf16 v[40:43], v[68:71], v[196:199], v[40:43]
    v_mfma_f32_16x16x32_bf16 v[32:35], v[68:71], v[192:195], v[32:35]
    ds_read_b64_tr_b16 v[68:69], v7 offset:53248
    ds_read_b64_tr_b16 v[70:71], v7 offset:54272
    s_waitcnt lgkmcnt(12)
    v_mfma_f32_16x16x32_bf16 v[48:51], v[72:75], v[192:195], v[48:51]
    v_mfma_f32_16x16x32_bf16 v[56:59], v[72:75], v[196:199], v[56:59]
    ds_read_b64_tr_b16 v[72:73], v7 offset:61440
    ds_read_b64_tr_b16 v[74:75], v7 offset:62464
    s_waitcnt lgkmcnt(12)
    v_mfma_f32_16x16x32_bf16 v[28:31], v[76:79], v[196:199], v[28:31]
    v_mfma_f32_16x16x32_bf16 v[20:23], v[76:79], v[192:195], v[20:23]
    ds_read_b64_tr_b16 v[76:77], v15 offset:45056
    ds_read_b64_tr_b16 v[78:79], v15 offset:46080
    s_waitcnt lgkmcnt(12)
    v_mfma_f32_16x16x32_bf16 v[36:39], v[80:83], v[192:195], v[36:39]
    v_mfma_f32_16x16x32_bf16 v[44:47], v[80:83], v[196:199], v[44:47]
    ds_read_b64_tr_b16 v[80:81], v15 offset:53248
    ds_read_b64_tr_b16 v[82:83], v15 offset:54272
    s_waitcnt lgkmcnt(12)
    v_mfma_f32_16x16x32_bf16 v[60:63], v[84:87], v[196:199], v[60:63]
    v_mfma_f32_16x16x32_bf16 v[52:55], v[84:87], v[192:195], v[52:55]
    ds_read_b64_tr_b16 v[84:85], v15 offset:61440
    ds_read_b64_tr_b16 v[86:87], v15 offset:62464
    s_waitcnt lgkmcnt(10)
    v_mfma_f32_16x16x32_bf16 v[16:19], v[64:67], v[200:203], v[16:19]
    v_mfma_f32_16x16x32_bf16 v[24:27], v[64:67], v[204:207], v[24:27]
    s_barrier
    ds_read_b128 v[208:211], v5 offset:24576
    ds_read_b128 v[212:215], v5 offset:26624
    ds_read_b64_tr_b16 v[64:65], v8 offset:0
    ds_read_b64_tr_b16 v[66:67], v8 offset:1024
    s_waitcnt lgkmcnt(12)
    v_mfma_f32_16x16x32_bf16 v[40:43], v[68:71], v[204:207], v[40:43]
    v_mfma_f32_16x16x32_bf16 v[32:35], v[68:71], v[200:203], v[32:35]
    ds_read_b64_tr_b16 v[68:69], v8 offset:8192
    ds_read_b64_tr_b16 v[70:71], v8 offset:9216
    s_waitcnt lgkmcnt(12)
    v_mfma_f32_16x16x32_bf16 v[48:51], v[72:75], v[200:203], v[48:51]
    v_mfma_f32_16x16x32_bf16 v[56:59], v[72:75], v[204:207], v[56:59]
    ds_read_b64_tr_b16 v[72:73], v8 offset:16384
    ds_read_b64_tr_b16 v[74:75], v8 offset:17408
    s_waitcnt lgkmcnt(12)
    v_mfma_f32_16x16x32_bf16 v[28:31], v[76:79], v[204:207], v[28:31]
    v_mfma_f32_16x16x32_bf16 v[20:23], v[76:79], v[200:203], v[20:23]
    ds_read_b64_tr_b16 v[76:77], v246 offset:0
    ds_read_b64_tr_b16 v[78:79], v246 offset:1024
    s_waitcnt lgkmcnt(12)
    v_mfma_f32_16x16x32_bf16 v[36:39], v[80:83], v[200:203], v[36:39]
    v_mfma_f32_16x16x32_bf16 v[44:47], v[80:83], v[204:207], v[44:47]
    ds_read_b64_tr_b16 v[80:81], v246 offset:8192
    ds_read_b64_tr_b16 v[82:83], v246 offset:9216
    s_waitcnt lgkmcnt(12)
    v_mfma_f32_16x16x32_bf16 v[60:63], v[84:87], v[204:207], v[60:63]
    v_mfma_f32_16x16x32_bf16 v[52:55], v[84:87], v[200:203], v[52:55]
    ds_read_b64_tr_b16 v[84:85], v246 offset:16384
    ds_read_b64_tr_b16 v[86:87], v246 offset:17408
    s_waitcnt lgkmcnt(10)
    v_mfma_f32_16x16x32_bf16 v[16:19], v[64:67], v[208:211], v[16:19]
    v_mfma_f32_16x16x32_bf16 v[24:27], v[64:67], v[212:215], v[24:27]
    ds_read_b128 v[216:219], v6 offset:24576
    ds_read_b128 v[220:223], v6 offset:26624
    ds_read_b64_tr_b16 v[64:65], v8 offset:4096
    ds_read_b64_tr_b16 v[66:67], v8 offset:5120
    s_waitcnt lgkmcnt(12)
    v_mfma_f32_16x16x32_bf16 v[40:43], v[68:71], v[212:215], v[40:43]
    v_mfma_f32_16x16x32_bf16 v[32:35], v[68:71], v[208:211], v[32:35]
    ds_read_b64_tr_b16 v[68:69], v8 offset:12288
    ds_read_b64_tr_b16 v[70:71], v8 offset:13312
    s_waitcnt lgkmcnt(12)
    v_mfma_f32_16x16x32_bf16 v[48:51], v[72:75], v[208:211], v[48:51]
    v_mfma_f32_16x16x32_bf16 v[56:59], v[72:75], v[212:215], v[56:59]
    ds_read_b64_tr_b16 v[72:73], v8 offset:20480
    ds_read_b64_tr_b16 v[74:75], v8 offset:21504
    s_waitcnt lgkmcnt(12)
    v_mfma_f32_16x16x32_bf16 v[28:31], v[76:79], v[212:215], v[28:31]
    v_mfma_f32_16x16x32_bf16 v[20:23], v[76:79], v[208:211], v[20:23]
    ds_read_b64_tr_b16 v[76:77], v246 offset:4096
    ds_read_b64_tr_b16 v[78:79], v246 offset:5120
    s_waitcnt lgkmcnt(12)
    v_mfma_f32_16x16x32_bf16 v[36:39], v[80:83], v[208:211], v[36:39]
    v_mfma_f32_16x16x32_bf16 v[44:47], v[80:83], v[212:215], v[44:47]
    ds_read_b64_tr_b16 v[80:81], v246 offset:12288
    ds_read_b64_tr_b16 v[82:83], v246 offset:13312
    s_waitcnt lgkmcnt(12)
    v_mfma_f32_16x16x32_bf16 v[60:63], v[84:87], v[212:215], v[60:63]
    v_mfma_f32_16x16x32_bf16 v[52:55], v[84:87], v[208:211], v[52:55]
    ds_read_b64_tr_b16 v[84:85], v246 offset:20480
    ds_read_b64_tr_b16 v[86:87], v246 offset:21504
    s_waitcnt lgkmcnt(10)
    v_mfma_f32_16x16x32_bf16 v[16:19], v[64:67], v[216:219], v[16:19]
    v_mfma_f32_16x16x32_bf16 v[24:27], v[64:67], v[220:223], v[24:27]
    s_barrier
    ds_read_b128 v[224:227], v5 offset:0
    ds_read_b128 v[228:231], v5 offset:2048
    ds_read_b64_tr_b16 v[64:65], v8 offset:24576
    ds_read_b64_tr_b16 v[66:67], v8 offset:25600
    s_waitcnt lgkmcnt(12)
    v_mfma_f32_16x16x32_bf16 v[40:43], v[68:71], v[220:223], v[40:43]
    v_mfma_f32_16x16x32_bf16 v[32:35], v[68:71], v[216:219], v[32:35]
    ds_read_b64_tr_b16 v[68:69], v246 offset:24576
    ds_read_b64_tr_b16 v[70:71], v246 offset:25600
    s_waitcnt lgkmcnt(12)
    v_mfma_f32_16x16x32_bf16 v[48:51], v[72:75], v[216:219], v[48:51]
    v_mfma_f32_16x16x32_bf16 v[56:59], v[72:75], v[220:223], v[56:59]
    ds_read_b128 v[232:235], v6 offset:0
    ds_read_b128 v[236:239], v6 offset:2048
    ds_read_b64_tr_b16 v[72:73], v8 offset:28672
    s_waitcnt lgkmcnt(13)
    ds_read_b64_tr_b16 v[74:75], v8 offset:29696
    v_mfma_f32_16x16x32_bf16 v[28:31], v[76:79], v[220:223], v[28:31]
    v_mfma_f32_16x16x32_bf16 v[20:23], v[76:79], v[216:219], v[20:23]
    ds_read_b64_tr_b16 v[76:77], v246 offset:28672
    s_waitcnt lgkmcnt(13)
    ds_read_b64_tr_b16 v[78:79], v246 offset:29696
    v_mfma_f32_16x16x32_bf16 v[36:39], v[80:83], v[216:219], v[36:39]
    v_mfma_f32_16x16x32_bf16 v[44:47], v[80:83], v[220:223], v[44:47]
    ds_read_b64_tr_b16 v[80:81], v8 offset:32768
    s_waitcnt lgkmcnt(13)
    ds_read_b64_tr_b16 v[82:83], v8 offset:33792
    v_mfma_f32_16x16x32_bf16 v[60:63], v[84:87], v[220:223], v[60:63]
    v_mfma_f32_16x16x32_bf16 v[52:55], v[84:87], v[216:219], v[52:55]
    ds_read_b64_tr_b16 v[84:85], v246 offset:32768
    s_waitcnt lgkmcnt(13)
    ds_read_b64_tr_b16 v[86:87], v246 offset:33792
    s_waitcnt lgkmcnt(12)
    v_mfma_f32_16x16x32_bf16 v[16:19], v[64:67], v[224:227], v[16:19]
    v_mfma_f32_16x16x32_bf16 v[24:27], v[64:67], v[228:231], v[24:27]
    ds_read_b64_tr_b16 v[64:65], v8 offset:36864
    ds_read_b64_tr_b16 v[66:67], v8 offset:37888
    s_waitcnt lgkmcnt(12)
    v_mfma_f32_16x16x32_bf16 v[28:31], v[68:71], v[228:231], v[28:31]
    v_mfma_f32_16x16x32_bf16 v[20:23], v[68:71], v[224:227], v[20:23]
    ds_read_b64_tr_b16 v[68:69], v246 offset:36864
    ds_read_b64_tr_b16 v[70:71], v246 offset:37888
    s_waitcnt lgkmcnt(10)
    v_mfma_f32_16x16x32_bf16 v[16:19], v[72:75], v[232:235], v[16:19]
    v_mfma_f32_16x16x32_bf16 v[24:27], v[72:75], v[236:239], v[24:27]
    ds_read_b64_tr_b16 v[72:73], v8 offset:40960
    ds_read_b64_tr_b16 v[74:75], v8 offset:41984
    s_waitcnt lgkmcnt(10)
    v_mfma_f32_16x16x32_bf16 v[28:31], v[76:79], v[236:239], v[28:31]
    v_mfma_f32_16x16x32_bf16 v[20:23], v[76:79], v[232:235], v[20:23]
    ds_read_b64_tr_b16 v[76:77], v246 offset:40960
    ds_read_b64_tr_b16 v[78:79], v246 offset:41984
    s_waitcnt lgkmcnt(10)
    v_mfma_f32_16x16x32_bf16 v[32:35], v[80:83], v[224:227], v[32:35]
    v_mfma_f32_16x16x32_bf16 v[40:43], v[80:83], v[228:231], v[40:43]
    ds_read_b64_tr_b16 v[80:81], v8 offset:45056
    ds_read_b64_tr_b16 v[82:83], v8 offset:46080
    s_waitcnt lgkmcnt(10)
    v_mfma_f32_16x16x32_bf16 v[44:47], v[84:87], v[228:231], v[44:47]
    v_mfma_f32_16x16x32_bf16 v[36:39], v[84:87], v[224:227], v[36:39]
    s_nop 1
    v_mul_f32 v16, v16, |v16|
    v_mul_f32 v17, v17, |v17|
    v_mul_f32 v18, v18, |v18|
    v_mul_f32 v19, v19, |v19|
    v_mul_f32 v20, v20, |v20|
    v_mul_f32 v21, v21, |v21|
    v_mul_f32 v22, v22, |v22|
    v_mul_f32 v23, v23, |v23|
    ds_read_b64_tr_b16 v[84:85], v246 offset:45056
    ds_read_b64_tr_b16 v[86:87], v246 offset:46080
    s_waitcnt lgkmcnt(10)
    v_mfma_f32_16x16x32_bf16 v[32:35], v[64:67], v[232:235], v[32:35]
    v_mfma_f32_16x16x32_bf16 v[40:43], v[64:67], v[236:239], v[40:43]
    v_cvt_pk_bf16_f32 v16, v16, v17
    v_cvt_pk_bf16_f32 v17, v18, v19
    v_cvt_pk_bf16_f32 v18, v20, v21
    v_cvt_pk_bf16_f32 v19, v22, v23
    v_pk_max_i16 v16, v16, 0
    v_pk_max_i16 v17, v17, 0
    v_pk_max_i16 v18, v18, 0
    v_pk_max_i16 v19, v19, 0
    s_waitcnt lgkmcnt(8)
    v_mfma_f32_16x16x32_bf16 v[44:47], v[68:71], v[236:239], v[44:47]
    v_mfma_f32_16x16x32_bf16 v[36:39], v[68:71], v[232:235], v[36:39]
    v_bfi_b32 v20, s63, v251, v16
    v_bfi_b32 v21, s63, v252, v17
    v_bfi_b32 v22, s63, v253, v18
    v_bfi_b32 v23, s63, v254, v19
    buffer_store_dwordx4 v[20:23], v12, s[44:47], s60 offen offset:0 sc1
    ds_write_b128 v12, v[16:19] offset:16384
    v_mul_f32 v24, v24, |v24|
    v_mul_f32 v25, v25, |v25|
    s_waitcnt lgkmcnt(7)
    v_mfma_f32_16x16x32_bf16 v[48:51], v[72:75], v[224:227], v[48:51]
    v_mfma_f32_16x16x32_bf16 v[56:59], v[72:75], v[228:231], v[56:59]
    v_mul_f32 v26, v26, |v26|
    v_mul_f32 v27, v27, |v27|
    v_mul_f32 v28, v28, |v28|
    v_mul_f32 v29, v29, |v29|
    v_mul_f32 v30, v30, |v30|
    v_mul_f32 v31, v31, |v31|
    v_cvt_pk_bf16_f32 v24, v24, v25
    v_cvt_pk_bf16_f32 v25, v26, v27
    s_waitcnt lgkmcnt(5)
    v_mfma_f32_16x16x32_bf16 v[60:63], v[76:79], v[228:231], v[60:63]
    v_mfma_f32_16x16x32_bf16 v[52:55], v[76:79], v[224:227], v[52:55]
    v_cvt_pk_bf16_f32 v26, v28, v29
    v_cvt_pk_bf16_f32 v27, v30, v31
    v_pk_max_i16 v24, v24, 0
    v_pk_max_i16 v25, v25, 0
    v_pk_max_i16 v26, v26, 0
    v_pk_max_i16 v27, v27, 0
    v_bfi_b32 v28, s63, v251, v24
    v_bfi_b32 v29, s63, v252, v25
    s_waitcnt lgkmcnt(3)
    v_mfma_f32_16x16x32_bf16 v[48:51], v[80:83], v[232:235], v[48:51]
    v_mfma_f32_16x16x32_bf16 v[56:59], v[80:83], v[236:239], v[56:59]
    v_bfi_b32 v30, s63, v253, v26
    v_bfi_b32 v31, s63, v254, v27
    buffer_store_dwordx4 v[28:31], v12, s[44:47], s60 offen offset:256 sc1
    ds_write_b128 v12, v[24:27] offset:16640
    v_mul_f32 v32, v32, |v32|
    v_mul_f32 v33, v33, |v33|
    v_mul_f32 v34, v34, |v34|
    v_mul_f32 v35, v35, |v35|
    s_waitcnt lgkmcnt(2)
    v_mfma_f32_16x16x32_bf16 v[60:63], v[84:87], v[236:239], v[60:63]
    v_mfma_f32_16x16x32_bf16 v[52:55], v[84:87], v[232:235], v[52:55]
    v_mul_f32 v36, v36, |v36|
    v_mul_f32 v37, v37, |v37|
    v_mul_f32 v38, v38, |v38|
    v_mul_f32 v39, v39, |v39|
    v_cvt_pk_bf16_f32 v32, v32, v33
    v_cvt_pk_bf16_f32 v33, v34, v35
    v_cvt_pk_bf16_f32 v34, v36, v37
    v_cvt_pk_bf16_f32 v35, v38, v39
    v_pk_max_i16 v32, v32, 0
    v_pk_max_i16 v33, v33, 0
    v_pk_max_i16 v34, v34, 0
    v_pk_max_i16 v35, v35, 0
    v_bfi_b32 v36, s63, v251, v32
    v_bfi_b32 v37, s63, v252, v33
    v_bfi_b32 v38, s63, v253, v34
    v_bfi_b32 v39, s63, v254, v35
    buffer_store_dwordx4 v[36:39], v12, s[44:47], s61 offen offset:0 sc1
    ds_write_b128 v12, v[32:35] offset:24576
    v_mul_f32 v40, v40, |v40|
    v_mul_f32 v41, v41, |v41|
    v_mul_f32 v42, v42, |v42|
    v_mul_f32 v43, v43, |v43|
    v_mul_f32 v44, v44, |v44|
    v_mul_f32 v45, v45, |v45|
    v_mul_f32 v46, v46, |v46|
    v_mul_f32 v47, v47, |v47|
    v_cvt_pk_bf16_f32 v40, v40, v41
    v_cvt_pk_bf16_f32 v41, v42, v43
    v_cvt_pk_bf16_f32 v42, v44, v45
    v_cvt_pk_bf16_f32 v43, v46, v47
    v_pk_max_i16 v40, v40, 0
    v_pk_max_i16 v41, v41, 0
    v_pk_max_i16 v42, v42, 0
    v_pk_max_i16 v43, v43, 0
    v_bfi_b32 v44, s63, v251, v40
    v_bfi_b32 v45, s63, v252, v41
    v_bfi_b32 v46, s63, v253, v42
    v_bfi_b32 v47, s63, v254, v43
    buffer_store_dwordx4 v[44:47], v12, s[44:47], s61 offen offset:256 sc1
    ds_write_b128 v12, v[40:43] offset:24832
    v_mul_f32 v48, v48, |v48|
    v_mul_f32 v49, v49, |v49|
    v_mul_f32 v50, v50, |v50|
    v_mul_f32 v51, v51, |v51|
    v_mul_f32 v52, v52, |v52|
    v_mul_f32 v53, v53, |v53|
    v_mul_f32 v54, v54, |v54|
    v_mul_f32 v55, v55, |v55|
    v_cvt_pk_bf16_f32 v48, v48, v49
    v_cvt_pk_bf16_f32 v49, v50, v51
    v_cvt_pk_bf16_f32 v50, v52, v53
    v_cvt_pk_bf16_f32 v51, v54, v55
    v_pk_max_i16 v48, v48, 0
    v_pk_max_i16 v49, v49, 0
    v_pk_max_i16 v50, v50, 0
    v_pk_max_i16 v51, v51, 0
    v_bfi_b32 v52, s63, v251, v48
    v_bfi_b32 v53, s63, v252, v49
    v_bfi_b32 v54, s63, v253, v50
    v_bfi_b32 v55, s63, v254, v51
    buffer_store_dwordx4 v[52:55], v12, s[44:47], s62 offen offset:0 sc1
    ds_write_b128 v12, v[48:51] offset:32768
    v_mul_f32 v56, v56, |v56|
    v_mul_f32 v57, v57, |v57|
    v_mul_f32 v58, v58, |v58|
    v_mul_f32 v59, v59, |v59|
    v_mul_f32 v60, v60, |v60|
    v_mul_f32 v61, v61, |v61|
    v_mul_f32 v62, v62, |v62|
    v_mul_f32 v63, v63, |v63|
    v_cvt_pk_bf16_f32 v56, v56, v57
    v_cvt_pk_bf16_f32 v57, v58, v59
    v_cvt_pk_bf16_f32 v58, v60, v61
    v_cvt_pk_bf16_f32 v59, v62, v63
    v_pk_max_i16 v56, v56, 0
    v_pk_max_i16 v57, v57, 0
    v_pk_max_i16 v58, v58, 0
    v_pk_max_i16 v59, v59, 0
    v_bfi_b32 v60, s63, v251, v56
    v_bfi_b32 v61, s63, v252, v57
    v_bfi_b32 v62, s63, v253, v58
    v_bfi_b32 v63, s63, v254, v59
    buffer_store_dwordx4 v[60:63], v12, s[44:47], s62 offen offset:256 sc1
    ds_write_b128 v12, v[56:59] offset:33024
    s_waitcnt lgkmcnt(0)
    s_barrier
    buffer_load_dword v249, v248, s[48:51], 0 offen offset:256
    ds_read_b128 v[96:99], v9 offset:16384
    ds_read_b64_tr_b16 v[64:65], v3 offset:49152
    ds_read_b64_tr_b16 v[66:67], v3 offset:51200
    ds_read_b64_tr_b16 v[68:69], v2 offset:0
    ds_read_b64_tr_b16 v[70:71], v2 offset:2048
    ds_read_b64_tr_b16 v[72:73], v2 offset:8192
    ds_read_b64_tr_b16 v[74:75], v2 offset:10240
    ds_read_b128 v[100:103], v9 offset:17408
    ds_read_b64_tr_b16 v[76:77], v3 offset:50176
    ds_read_b64_tr_b16 v[78:79], v3 offset:52224
    ds_read_b64_tr_b16 v[80:81], v2 offset:1024
    ds_read_b64_tr_b16 v[82:83], v2 offset:3072
    ds_read_b64_tr_b16 v[84:85], v2 offset:9216
    ds_read_b64_tr_b16 v[86:87], v2 offset:11264
    s_waitcnt lgkmcnt(11)
    v_mfma_f32_32x32x16_bf16 v[16:31], v[64:67], v[96:99], 0
    ds_read_b128 v[104:107], v9 offset:18432
    ds_read_b64_tr_b16 v[64:65], v3 offset:53248
    ds_read_b64_tr_b16 v[66:67], v3 offset:55296
    s_waitcnt lgkmcnt(12)
    v_mfma_f32_32x32x16_bf16 v[32:47], v[68:71], v[96:99], 0
    ds_read_b64_tr_b16 v[68:69], v2 offset:4096
    ds_read_b64_tr_b16 v[70:71], v2 offset:6144
    s_waitcnt lgkmcnt(12)
    v_mfma_f32_32x32x16_bf16 v[48:63], v[72:75], v[96:99], 0
    ds_read_b64_tr_b16 v[72:73], v2 offset:12288
    ds_read_b64_tr_b16 v[74:75], v2 offset:14336
    s_waitcnt lgkmcnt(11)
    v_mfma_f32_32x32x16_bf16 v[16:31], v[76:79], v[100:103], v[16:31]
    ds_read_b128 v[108:111], v9 offset:19456
    ds_read_b64_tr_b16 v[76:77], v3 offset:54272
    ds_read_b64_tr_b16 v[78:79], v3 offset:56320
    s_waitcnt lgkmcnt(12)
    v_mfma_f32_32x32x16_bf16 v[32:47], v[80:83], v[100:103], v[32:47]
    ds_read_b64_tr_b16 v[80:81], v2 offset:5120
    ds_read_b64_tr_b16 v[82:83], v2 offset:7168
    s_waitcnt lgkmcnt(12)
    v_mfma_f32_32x32x16_bf16 v[48:63], v[84:87], v[100:103], v[48:63]
    ds_read_b64_tr_b16 v[84:85], v2 offset:13312
    ds_read_b64_tr_b16 v[86:87], v2 offset:15360
    s_waitcnt lgkmcnt(11)
    v_mfma_f32_32x32x16_bf16 v[16:31], v[64:67], v[104:107], v[16:31]
    s_barrier
    ds_read_b128 v[112:115], v9 offset:24576
    ds_read_b64_tr_b16 v[64:65], v3 offset:57344
    ds_read_b64_tr_b16 v[66:67], v3 offset:59392
    s_waitcnt lgkmcnt(12)
    v_mfma_f32_32x32x16_bf16 v[32:47], v[68:71], v[104:107], v[32:47]
    ds_read_b64_tr_b16 v[68:69], v4 offset:8192
    ds_read_b64_tr_b16 v[70:71], v4 offset:10240
    s_waitcnt lgkmcnt(12)
    v_mfma_f32_32x32x16_bf16 v[48:63], v[72:75], v[104:107], v[48:63]
    ds_read_b64_tr_b16 v[72:73], v2 offset:40960
    ds_read_b64_tr_b16 v[74:75], v2 offset:43008
    s_waitcnt lgkmcnt(11)
    v_mfma_f32_32x32x16_bf16 v[16:31], v[76:79], v[108:111], v[16:31]
    ds_read_b128 v[116:119], v9 offset:25600
    ds_read_b64_tr_b16 v[76:77], v3 offset:58368
    ds_read_b64_tr_b16 v[78:79], v3 offset:60416
    s_waitcnt lgkmcnt(12)
    v_mfma_f32_32x32x16_bf16 v[32:47], v[80:83], v[108:111], v[32:47]
    ds_read_b64_tr_b16 v[80:81], v4 offset:9216
    ds_read_b64_tr_b16 v[82:83], v4 offset:11264
    s_waitcnt lgkmcnt(12)
    v_mfma_f32_32x32x16_bf16 v[48:63], v[84:87], v[108:111], v[48:63]
    ds_read_b64_tr_b16 v[84:85], v2 offset:41984
    ds_read_b64_tr_b16 v[86:87], v2 offset:44032
    s_waitcnt lgkmcnt(11)
    v_mfma_f32_32x32x16_bf16 v[16:31], v[64:67], v[112:115], v[16:31]
    ds_read_b128 v[120:123], v9 offset:26624
    ds_read_b64_tr_b16 v[64:65], v3 offset:61440
    ds_read_b64_tr_b16 v[66:67], v3 offset:63488
    s_waitcnt lgkmcnt(12)
    v_mfma_f32_32x32x16_bf16 v[32:47], v[68:71], v[112:115], v[32:47]
    ds_read_b64_tr_b16 v[68:69], v4 offset:12288
    ds_read_b64_tr_b16 v[70:71], v4 offset:14336
    s_waitcnt lgkmcnt(12)
    v_mfma_f32_32x32x16_bf16 v[48:63], v[72:75], v[112:115], v[48:63]
    ds_read_b64_tr_b16 v[72:73], v2 offset:45056
    ds_read_b64_tr_b16 v[74:75], v2 offset:47104
    s_waitcnt lgkmcnt(11)
    v_mfma_f32_32x32x16_bf16 v[16:31], v[76:79], v[116:119], v[16:31]
    ds_read_b128 v[124:127], v9 offset:27648
    ds_read_b64_tr_b16 v[76:77], v3 offset:62464
    ds_read_b64_tr_b16 v[78:79], v3 offset:64512
    s_waitcnt lgkmcnt(12)
    v_mfma_f32_32x32x16_bf16 v[32:47], v[80:83], v[116:119], v[32:47]
    ds_read_b64_tr_b16 v[80:81], v4 offset:13312
    ds_read_b64_tr_b16 v[82:83], v4 offset:15360
    s_waitcnt lgkmcnt(12)
    v_mfma_f32_32x32x16_bf16 v[48:63], v[84:87], v[116:119], v[48:63]
    ds_read_b64_tr_b16 v[84:85], v2 offset:46080
    ds_read_b64_tr_b16 v[86:87], v2 offset:48128
    s_waitcnt lgkmcnt(11)
    v_mfma_f32_32x32x16_bf16 v[16:31], v[64:67], v[120:123], v[16:31]
    s_barrier
    ds_read_b128 v[128:131], v9 offset:32768
    ds_read_b64_tr_b16 v[64:65], v2 offset:49152
    ds_read_b64_tr_b16 v[66:67], v2 offset:51200
    s_waitcnt lgkmcnt(12)
    v_mfma_f32_32x32x16_bf16 v[32:47], v[68:71], v[120:123], v[32:47]
    ds_read_b64_tr_b16 v[68:69], v2 offset:57344
    ds_read_b64_tr_b16 v[70:71], v2 offset:59392
    s_waitcnt lgkmcnt(12)
    v_mfma_f32_32x32x16_bf16 v[48:63], v[72:75], v[120:123], v[48:63]
    ds_read_b64_tr_b16 v[72:73], v4 offset:16384
    ds_read_b64_tr_b16 v[74:75], v4 offset:18432
    s_waitcnt lgkmcnt(11)
    v_mfma_f32_32x32x16_bf16 v[16:31], v[76:79], v[124:127], v[16:31]
    ds_read_b128 v[132:135], v9 offset:33792
    ds_read_b64_tr_b16 v[76:77], v2 offset:50176
    ds_read_b64_tr_b16 v[78:79], v2 offset:52224
    s_waitcnt lgkmcnt(12)
    v_mfma_f32_32x32x16_bf16 v[32:47], v[80:83], v[124:127], v[32:47]
    ds_read_b64_tr_b16 v[80:81], v2 offset:58368
    ds_read_b64_tr_b16 v[82:83], v2 offset:60416
    s_waitcnt lgkmcnt(12)
    v_mfma_f32_32x32x16_bf16 v[48:63], v[84:87], v[124:127], v[48:63]
    ds_read_b64_tr_b16 v[84:85], v4 offset:17408
    ds_read_b64_tr_b16 v[86:87], v4 offset:19456
    s_waitcnt lgkmcnt(11)
    v_mfma_f32_32x32x16_bf16 v[16:31], v[64:67], v[128:131], v[16:31]
    ds_read_b128 v[136:139], v9 offset:34816
    ds_read_b64_tr_b16 v[64:65], v2 offset:53248
    ds_read_b64_tr_b16 v[66:67], v2 offset:55296
    s_waitcnt lgkmcnt(12)
    v_mfma_f32_32x32x16_bf16 v[32:47], v[68:71], v[128:131], v[32:47]
    ds_read_b64_tr_b16 v[68:69], v2 offset:61440
    ds_read_b64_tr_b16 v[70:71], v2 offset:63488
    s_waitcnt lgkmcnt(12)
    v_mfma_f32_32x32x16_bf16 v[48:63], v[72:75], v[128:131], v[48:63]
    ds_read_b64_tr_b16 v[72:73], v4 offset:20480
    ds_read_b64_tr_b16 v[74:75], v4 offset:22528
    s_waitcnt lgkmcnt(11)
    v_mfma_f32_32x32x16_bf16 v[16:31], v[76:79], v[132:135], v[16:31]
    ds_read_b128 v[140:143], v9 offset:35840
    ds_read_b64_tr_b16 v[76:77], v2 offset:54272
    ds_read_b64_tr_b16 v[78:79], v2 offset:56320
    s_waitcnt lgkmcnt(12)
    v_mfma_f32_32x32x16_bf16 v[32:47], v[80:83], v[132:135], v[32:47]
    ds_read_b64_tr_b16 v[80:81], v2 offset:62464
    ds_read_b64_tr_b16 v[82:83], v2 offset:64512
    s_waitcnt lgkmcnt(12)
    v_mfma_f32_32x32x16_bf16 v[48:63], v[84:87], v[132:135], v[48:63]
    ds_read_b64_tr_b16 v[84:85], v4 offset:21504
    ds_read_b64_tr_b16 v[86:87], v4 offset:23552
    s_waitcnt lgkmcnt(11)
    v_mfma_f32_32x32x16_bf16 v[16:31], v[64:67], v[136:139], v[16:31]
    s_waitcnt lgkmcnt(9)
    v_mfma_f32_32x32x16_bf16 v[32:47], v[68:71], v[136:139], v[32:47]
    s_waitcnt lgkmcnt(7)
    v_mfma_f32_32x32x16_bf16 v[48:63], v[72:75], v[136:139], v[48:63]
    s_waitcnt lgkmcnt(4)
    v_mfma_f32_32x32x16_bf16 v[16:31], v[76:79], v[140:143], v[16:31]
    s_barrier
    ds_read_b128 v[144:147], v10 offset:0
    ds_read_b64_tr_b16 v[64:65], v3 offset:16384
    ds_read_b64_tr_b16 v[66:67], v3 offset:18432
    ds_read_b128 v[148:151], v10 offset:1024
    ds_read_b64_tr_b16 v[68:69], v3 offset:17408
    ds_read_b64_tr_b16 v[70:71], v3 offset:19456
    ds_read_b128 v[152:155], v10 offset:2048
    ds_read_b64_tr_b16 v[72:73], v3 offset:20480
    ds_read_b64_tr_b16 v[74:75], v3 offset:22528
    ds_read_b128 v[156:159], v10 offset:3072
    ds_read_b64_tr_b16 v[76:77], v3 offset:21504
    s_waitcnt lgkmcnt(13)
    ds_read_b64_tr_b16 v[78:79], v3 offset:23552
    v_mfma_f32_32x32x16_bf16 v[32:47], v[80:83], v[140:143], v[32:47]
    ds_read_b64_tr_b16 v[80:81], v4 offset:24576
    s_waitcnt lgkmcnt(13)
    ds_read_b64_tr_b16 v[82:83], v4 offset:26624
    v_mfma_f32_32x32x16_bf16 v[48:63], v[84:87], v[140:143], v[48:63]
    ds_read_b64_tr_b16 v[84:85], v4 offset:25600
    s_waitcnt lgkmcnt(13)
    ds_read_b64_tr_b16 v[86:87], v4 offset:27648
    s_waitcnt lgkmcnt(13)
    v_mfma_f32_32x32x16_bf16 v[16:31], v[64:67], v[144:147], v[16:31]
    ds_read_b64_tr_b16 v[64:65], v4 offset:28672
    ds_read_b64_tr_b16 v[66:67], v4 offset:30720
    s_waitcnt lgkmcnt(12)
    v_mfma_f32_32x32x16_bf16 v[16:31], v[68:71], v[148:151], v[16:31]
    ds_read_b64_tr_b16 v[68:69], v4 offset:29696
    ds_read_b64_tr_b16 v[70:71], v4 offset:31744
    s_waitcnt lgkmcnt(11)
    v_mfma_f32_32x32x16_bf16 v[16:31], v[72:75], v[152:155], v[16:31]
    ds_read_b128 v[160:163], v10 offset:8192
    ds_read_b64_tr_b16 v[72:73], v3 offset:24576
    ds_read_b64_tr_b16 v[74:75], v3 offset:26624
    s_waitcnt lgkmcnt(11)
    v_mfma_f32_32x32x16_bf16 v[16:31], v[76:79], v[156:159], v[16:31]
    ds_read_b128 v[164:167], v10 offset:9216
    ds_read_b64_tr_b16 v[76:77], v3 offset:25600
    ds_read_b64_tr_b16 v[78:79], v3 offset:27648
    s_waitcnt lgkmcnt(12)
    v_mfma_f32_32x32x16_bf16 v[32:47], v[80:83], v[144:147], v[32:47]
    ds_read_b128 v[168:171], v10 offset:10240
    ds_read_b64_tr_b16 v[80:81], v3 offset:28672
    ds_read_b64_tr_b16 v[82:83], v3 offset:30720
    s_waitcnt lgkmcnt(13)
    v_mfma_f32_32x32x16_bf16 v[32:47], v[84:87], v[148:151], v[32:47]
    ds_read_b128 v[172:175], v10 offset:11264
    ds_read_b64_tr_b16 v[84:85], v3 offset:29696
    s_waitcnt lgkmcnt(13)
    ds_read_b64_tr_b16 v[86:87], v3 offset:31744
    v_mfma_f32_32x32x16_bf16 v[32:47], v[64:67], v[152:155], v[32:47]
    s_barrier
    ds_read_b64_tr_b16 v[64:65], v3 offset:40960
    s_waitcnt lgkmcnt(13)
    ds_read_b64_tr_b16 v[66:67], v3 offset:43008
    v_mfma_f32_32x32x16_bf16 v[32:47], v[68:71], v[156:159], v[32:47]
    ds_read_b64_tr_b16 v[68:69], v3 offset:41984
    s_waitcnt lgkmcnt(13)
    ds_read_b64_tr_b16 v[70:71], v3 offset:44032
    s_waitcnt lgkmcnt(13)
    v_mfma_f32_32x32x16_bf16 v[16:31], v[72:75], v[160:163], v[16:31]
    ds_read_b64_tr_b16 v[72:73], v3 offset:45056
    ds_read_b64_tr_b16 v[74:75], v3 offset:47104
    s_waitcnt lgkmcnt(12)
    v_mfma_f32_32x32x16_bf16 v[16:31], v[76:79], v[164:167], v[16:31]
    ds_read_b64_tr_b16 v[76:77], v3 offset:46080
    ds_read_b64_tr_b16 v[78:79], v3 offset:48128
    s_waitcnt lgkmcnt(11)
    v_mfma_f32_32x32x16_bf16 v[16:31], v[80:83], v[168:171], v[16:31]
    ds_read_b128 v[176:179], v10 offset:32768
    ds_read_b64_tr_b16 v[80:81], v4 offset:0
    ds_read_b64_tr_b16 v[82:83], v4 offset:2048
    s_waitcnt lgkmcnt(11)
    v_mfma_f32_32x32x16_bf16 v[16:31], v[84:87], v[172:175], v[16:31]
    ds_read_b128 v[180:183], v10 offset:33792
    ds_read_b64_tr_b16 v[84:85], v4 offset:1024
    ds_read_b64_tr_b16 v[86:87], v4 offset:3072
    s_waitcnt lgkmcnt(12)
    v_mfma_f32_32x32x16_bf16 v[32:47], v[64:67], v[160:163], v[32:47]
    ds_read_b128 v[184:187], v10 offset:34816
    ds_read_b64_tr_b16 v[64:65], v4 offset:4096
    ds_read_b64_tr_b16 v[66:67], v4 offset:6144
    s_waitcnt lgkmcnt(13)
    v_mfma_f32_32x32x16_bf16 v[32:47], v[68:71], v[164:167], v[32:47]
    ds_read_b128 v[188:191], v10 offset:35840
    ds_read_b64_tr_b16 v[68:69], v4 offset:5120
    s_waitcnt lgkmcnt(13)
    ds_read_b64_tr_b16 v[70:71], v4 offset:7168
    v_mfma_f32_32x32x16_bf16 v[32:47], v[72:75], v[168:171], v[32:47]
    ds_read_b64_tr_b16 v[72:73], v2 offset:0
    s_waitcnt lgkmcnt(13)
    ds_read_b64_tr_b16 v[74:75], v2 offset:2048
    v_mfma_f32_32x32x16_bf16 v[32:47], v[76:79], v[172:175], v[32:47]
    ds_read_b64_tr_b16 v[76:77], v2 offset:1024
    s_waitcnt lgkmcnt(13)
    ds_read_b64_tr_b16 v[78:79], v2 offset:3072
    s_waitcnt lgkmcnt(13)
    v_mfma_f32_32x32x16_bf16 v[16:31], v[80:83], v[176:179], v[16:31]
    ds_read_b64_tr_b16 v[80:81], v2 offset:4096
    ds_read_b64_tr_b16 v[82:83], v2 offset:6144
    s_waitcnt lgkmcnt(12)
    v_mfma_f32_32x32x16_bf16 v[16:31], v[84:87], v[180:183], v[16:31]
    ds_read_b64_tr_b16 v[84:85], v2 offset:5120
    ds_read_b64_tr_b16 v[86:87], v2 offset:7168
    s_waitcnt lgkmcnt(11)
    v_mfma_f32_32x32x16_bf16 v[16:31], v[64:67], v[184:187], v[16:31]
    s_barrier
    ds_read_b128 v[192:195], v9 offset:8192
    ds_read_b64_tr_b16 v[64:65], v3 offset:49152
    ds_read_b64_tr_b16 v[66:67], v3 offset:51200
    s_waitcnt lgkmcnt(11)
    v_mfma_f32_32x32x16_bf16 v[16:31], v[68:71], v[188:191], v[16:31]
    ds_read_b128 v[196:199], v9 offset:9216
    ds_read_b64_tr_b16 v[68:69], v3 offset:50176
    ds_read_b64_tr_b16 v[70:71], v3 offset:52224
    s_waitcnt lgkmcnt(12)
    v_mfma_f32_32x32x16_bf16 v[32:47], v[72:75], v[176:179], v[32:47]
    ds_read_b128 v[200:203], v9 offset:10240
    ds_read_b64_tr_b16 v[72:73], v3 offset:53248
    ds_read_b64_tr_b16 v[74:75], v3 offset:55296
    s_waitcnt lgkmcnt(13)
    v_mfma_f32_32x32x16_bf16 v[32:47], v[76:79], v[180:183], v[32:47]
    ds_read_b128 v[204:207], v9 offset:11264
    ds_read_b64_tr_b16 v[76:77], v3 offset:54272
    s_waitcnt lgkmcnt(13)
    ds_read_b64_tr_b16 v[78:79], v3 offset:56320
    v_mfma_f32_32x32x16_bf16 v[32:47], v[80:83], v[184:187], v[32:47]
    ds_read_b64_tr_b16 v[80:81], v2 offset:24576
    s_waitcnt lgkmcnt(13)
    ds_read_b64_tr_b16 v[82:83], v2 offset:26624
    v_mfma_f32_32x32x16_bf16 v[32:47], v[84:87], v[188:191], v[32:47]
    ds_read_b64_tr_b16 v[84:85], v2 offset:25600
    s_waitcnt lgkmcnt(13)
    ds_read_b64_tr_b16 v[86:87], v2 offset:27648
    s_waitcnt lgkmcnt(13)
    v_mfma_f32_32x32x16_bf16 v[16:31], v[64:67], v[192:195], v[16:31]
    ds_read_b64_tr_b16 v[64:65], v2 offset:28672
    ds_read_b64_tr_b16 v[66:67], v2 offset:30720
    s_waitcnt lgkmcnt(12)
    v_mfma_f32_32x32x16_bf16 v[16:31], v[68:71], v[196:199], v[16:31]
    ds_read_b64_tr_b16 v[68:69], v2 offset:29696
    ds_read_b64_tr_b16 v[70:71], v2 offset:31744
    s_waitcnt lgkmcnt(11)
    v_mfma_f32_32x32x16_bf16 v[16:31], v[72:75], v[200:203], v[16:31]
    ds_read_b128 v[208:211], v9 offset:16384
    ds_read_b64_tr_b16 v[72:73], v2 offset:40960
    ds_read_b64_tr_b16 v[74:75], v2 offset:43008
    s_waitcnt lgkmcnt(11)
    v_mfma_f32_32x32x16_bf16 v[16:31], v[76:79], v[204:207], v[16:31]
    ds_read_b128 v[212:215], v9 offset:17408
    ds_read_b64_tr_b16 v[76:77], v2 offset:41984
    ds_read_b64_tr_b16 v[78:79], v2 offset:44032
    s_waitcnt lgkmcnt(12)
    v_mfma_f32_32x32x16_bf16 v[32:47], v[80:83], v[192:195], v[32:47]
    ds_read_b128 v[216:219], v9 offset:18432
    ds_read_b64_tr_b16 v[80:81], v2 offset:45056
    ds_read_b64_tr_b16 v[82:83], v2 offset:47104
    s_waitcnt lgkmcnt(13)
    v_mfma_f32_32x32x16_bf16 v[32:47], v[84:87], v[196:199], v[32:47]
    ds_read_b128 v[220:223], v9 offset:19456
    ds_read_b64_tr_b16 v[84:85], v2 offset:46080
    s_waitcnt lgkmcnt(13)
    ds_read_b64_tr_b16 v[86:87], v2 offset:48128
    v_mfma_f32_32x32x16_bf16 v[32:47], v[64:67], v[200:203], v[32:47]
    s_barrier
    ds_read_b128 v[224:227], v10 offset:57344
    s_waitcnt lgkmcnt(13)
    ds_read_b64_tr_b16 v[64:65], v4 offset:8192
    ds_read_b64_tr_b16 v[66:67], v4 offset:10240
    v_mfma_f32_32x32x16_bf16 v[32:47], v[68:71], v[204:207], v[32:47]
    s_waitcnt lgkmcnt(13)
    ds_read_b128 v[228:231], v10 offset:58368
    ds_read_b64_tr_b16 v[68:69], v4 offset:9216
    s_waitcnt lgkmcnt(13)
    ds_read_b64_tr_b16 v[70:71], v4 offset:11264
    v_mfma_f32_32x32x16_bf16 v[16:31], v[72:75], v[208:211], v[16:31]
    ds_read_b128 v[232:235], v10 offset:59392
    s_waitcnt lgkmcnt(13)
    ds_read_b64_tr_b16 v[72:73], v4 offset:12288
    ds_read_b64_tr_b16 v[74:75], v4 offset:14336
    v_mfma_f32_32x32x16_bf16 v[16:31], v[76:79], v[212:215], v[16:31]
    s_waitcnt lgkmcnt(13)
    ds_read_b128 v[236:239], v10 offset:60416
    ds_read_b64_tr_b16 v[76:77], v4 offset:13312
    s_waitcnt lgkmcnt(13)
    ds_read_b64_tr_b16 v[78:79], v4 offset:15360
    v_mfma_f32_32x32x16_bf16 v[16:31], v[80:83], v[216:219], v[16:31]
    ds_read_b64_tr_b16 v[80:81], v2 offset:49152
    s_waitcnt lgkmcnt(13)
    ds_read_b64_tr_b16 v[82:83], v2 offset:51200
    v_mfma_f32_32x32x16_bf16 v[16:31], v[84:87], v[220:223], v[16:31]
    ds_read_b64_tr_b16 v[84:85], v2 offset:50176
    s_waitcnt lgkmcnt(13)
    ds_read_b64_tr_b16 v[86:87], v2 offset:52224
    s_waitcnt lgkmcnt(13)
    v_mfma_f32_32x32x16_bf16 v[16:31], v[64:67], v[224:227], v[16:31]
    ds_read_b64_tr_b16 v[64:65], v2 offset:53248
    ds_read_b64_tr_b16 v[66:67], v2 offset:55296
    s_waitcnt lgkmcnt(12)
    v_mfma_f32_32x32x16_bf16 v[16:31], v[68:71], v[228:231], v[16:31]
    ds_read_b64_tr_b16 v[68:69], v2 offset:54272
    ds_read_b64_tr_b16 v[70:71], v2 offset:56320
    s_waitcnt lgkmcnt(11)
    v_mfma_f32_32x32x16_bf16 v[16:31], v[72:75], v[232:235], v[16:31]
    ds_read_b64_tr_b16 v[72:73], v2 offset:32768
    ds_read_b64_tr_b16 v[74:75], v2 offset:34816
    s_waitcnt lgkmcnt(10)
    v_mfma_f32_32x32x16_bf16 v[16:31], v[76:79], v[236:239], v[16:31]
    ds_read_b64_tr_b16 v[76:77], v2 offset:33792
    ds_read_b64_tr_b16 v[78:79], v2 offset:35840
    s_waitcnt lgkmcnt(10)
    v_mfma_f32_32x32x16_bf16 v[32:47], v[80:83], v[224:227], v[32:47]
    ds_read_b64_tr_b16 v[80:81], v2 offset:36864
    ds_read_b64_tr_b16 v[82:83], v2 offset:38912
    s_waitcnt lgkmcnt(10)
    v_mfma_f32_32x32x16_bf16 v[32:47], v[84:87], v[228:231], v[32:47]
    s_nop 3
    v_cvt_pk_bf16_f32 v16, v16, v17
    v_cvt_pk_bf16_f32 v17, v18, v19
    v_cvt_pk_bf16_f32 v18, v20, v21
    v_cvt_pk_bf16_f32 v19, v22, v23
    s_nop 1
    v_permlane32_swap_b32 v16, v18
    ds_read_b64_tr_b16 v[84:85], v2 offset:37888
    ds_read_b64_tr_b16 v[86:87], v2 offset:39936
    s_waitcnt lgkmcnt(10)
    v_mfma_f32_32x32x16_bf16 v[32:47], v[64:67], v[232:235], v[32:47]
    v_permlane32_swap_b32 v17, v19
    v_bfi_b32 v16, s63, v251, v16
    v_bfi_b32 v18, s63, v253, v18
    v_bfi_b32 v17, s63, v252, v17
    v_bfi_b32 v19, s63, v254, v19
    buffer_store_dwordx4 v[16:19], v250, s[44:47], s38 offen offset:0 sc1
    s_barrier
    ds_read_b64_tr_b16 v[64:65], v2 offset:57344
    ds_read_b64_tr_b16 v[66:67], v2 offset:59392
    s_waitcnt lgkmcnt(10)
    v_mfma_f32_32x32x16_bf16 v[32:47], v[68:71], v[236:239], v[32:47]
    v_cvt_pk_bf16_f32 v24, v24, v25
    v_cvt_pk_bf16_f32 v25, v26, v27
    v_cvt_pk_bf16_f32 v26, v28, v29
    v_cvt_pk_bf16_f32 v27, v30, v31
    s_nop 1
    v_permlane32_swap_b32 v24, v26
    ds_read_b64_tr_b16 v[68:69], v2 offset:58368
    ds_read_b64_tr_b16 v[70:71], v2 offset:60416
    s_waitcnt lgkmcnt(10)
    v_mfma_f32_32x32x16_bf16 v[32:47], v[72:75], v[208:211], v[32:47]
    v_permlane32_swap_b32 v25, v27
    v_bfi_b32 v24, s63, v251, v24
    v_bfi_b32 v26, s63, v253, v26
    v_bfi_b32 v25, s63, v252, v25
    v_bfi_b32 v27, s63, v254, v27
    buffer_store_dwordx4 v[24:27], v250, s[44:47], s38 offen offset:256 sc1
    ds_read_b64_tr_b16 v[72:73], v2 offset:61440
    ds_read_b64_tr_b16 v[74:75], v2 offset:63488
    s_waitcnt lgkmcnt(10)
    v_mfma_f32_32x32x16_bf16 v[32:47], v[76:79], v[212:215], v[32:47]
    ds_read_b64_tr_b16 v[76:77], v2 offset:62464
    ds_read_b64_tr_b16 v[78:79], v2 offset:64512
    s_waitcnt lgkmcnt(10)
    v_mfma_f32_32x32x16_bf16 v[32:47], v[80:83], v[216:219], v[32:47]
    ds_read_b64_tr_b16 v[80:81], v4 offset:16384
    ds_read_b64_tr_b16 v[82:83], v4 offset:18432
    s_waitcnt lgkmcnt(10)
    v_mfma_f32_32x32x16_bf16 v[32:47], v[84:87], v[220:223], v[32:47]
    ds_read_b64_tr_b16 v[84:85], v4 offset:17408
    ds_read_b64_tr_b16 v[86:87], v4 offset:19456
    s_waitcnt lgkmcnt(10)
    v_mfma_f32_32x32x16_bf16 v[48:63], v[64:67], v[144:147], v[48:63]
    ds_read_b64_tr_b16 v[64:65], v4 offset:20480
    ds_read_b64_tr_b16 v[66:67], v4 offset:22528
    s_waitcnt lgkmcnt(10)
    v_mfma_f32_32x32x16_bf16 v[48:63], v[68:71], v[148:151], v[48:63]
    s_nop 3
    v_cvt_pk_bf16_f32 v32, v32, v33
    v_cvt_pk_bf16_f32 v33, v34, v35
    v_cvt_pk_bf16_f32 v34, v36, v37
    v_cvt_pk_bf16_f32 v35, v38, v39
    s_nop 1
    v_permlane32_swap_b32 v32, v34
    ds_read_b64_tr_b16 v[68:69], v4 offset:21504
    ds_read_b64_tr_b16 v[70:71], v4 offset:23552
    s_waitcnt lgkmcnt(10)
    v_mfma_f32_32x32x16_bf16 v[48:63], v[72:75], v[152:155], v[48:63]
    v_permlane32_swap_b32 v33, v35
    v_bfi_b32 v32, s63, v251, v32
    v_bfi_b32 v34, s63, v253, v34
    v_bfi_b32 v33, s63, v252, v33
    v_bfi_b32 v35, s63, v254, v35
    buffer_store_dwordx4 v[32:35], v250, s[44:47], s10 offen offset:0 sc1
    ds_read_b64_tr_b16 v[72:73], v3 offset:0
    ds_read_b64_tr_b16 v[74:75], v3 offset:2048
    s_waitcnt lgkmcnt(10)
    v_mfma_f32_32x32x16_bf16 v[48:63], v[76:79], v[156:159], v[48:63]
    v_cvt_pk_bf16_f32 v40, v40, v41
    v_cvt_pk_bf16_f32 v41, v42, v43
    v_cvt_pk_bf16_f32 v42, v44, v45
    v_cvt_pk_bf16_f32 v43, v46, v47
    s_nop 1
    v_permlane32_swap_b32 v40, v42
    ds_read_b64_tr_b16 v[76:77], v3 offset:1024
    ds_read_b64_tr_b16 v[78:79], v3 offset:3072
    s_waitcnt lgkmcnt(10)
    v_mfma_f32_32x32x16_bf16 v[48:63], v[80:83], v[160:163], v[48:63]
    v_permlane32_swap_b32 v41, v43
    v_bfi_b32 v40, s63, v251, v40
    v_bfi_b32 v42, s63, v253, v42
    v_bfi_b32 v41, s63, v252, v41
    v_bfi_b32 v43, s63, v254, v43
    buffer_store_dwordx4 v[40:43], v250, s[44:47], s10 offen offset:256 sc1
    ds_read_b64_tr_b16 v[80:81], v3 offset:4096
    ds_read_b64_tr_b16 v[82:83], v3 offset:6144
    s_waitcnt lgkmcnt(10)
    v_mfma_f32_32x32x16_bf16 v[48:63], v[84:87], v[164:167], v[48:63]
    ds_read_b64_tr_b16 v[84:85], v3 offset:5120
    ds_read_b64_tr_b16 v[86:87], v3 offset:7168
    s_waitcnt lgkmcnt(10)
    v_mfma_f32_32x32x16_bf16 v[48:63], v[64:67], v[168:171], v[48:63]
    s_barrier
    ds_read_b64_tr_b16 v[64:65], v3 offset:8192
    ds_read_b64_tr_b16 v[66:67], v3 offset:10240
    s_waitcnt lgkmcnt(10)
    v_mfma_f32_32x32x16_bf16 v[48:63], v[68:71], v[172:175], v[48:63]
    ds_read_b64_tr_b16 v[68:69], v3 offset:9216
    ds_read_b64_tr_b16 v[70:71], v3 offset:11264
    s_waitcnt lgkmcnt(10)
    v_mfma_f32_32x32x16_bf16 v[48:63], v[72:75], v[176:179], v[48:63]
    ds_read_b64_tr_b16 v[72:73], v3 offset:12288
    ds_read_b64_tr_b16 v[74:75], v3 offset:14336
    s_waitcnt lgkmcnt(10)
    v_mfma_f32_32x32x16_bf16 v[48:63], v[76:79], v[180:183], v[48:63]
    ds_read_b64_tr_b16 v[76:77], v3 offset:13312
    ds_read_b64_tr_b16 v[78:79], v3 offset:15360
    s_waitcnt lgkmcnt(10)
    v_mfma_f32_32x32x16_bf16 v[48:63], v[80:83], v[184:187], v[48:63]
    ds_read_b64_tr_b16 v[80:81], v3 offset:16384
    ds_read_b64_tr_b16 v[82:83], v3 offset:18432
    s_waitcnt lgkmcnt(10)
    v_mfma_f32_32x32x16_bf16 v[48:63], v[84:87], v[188:191], v[48:63]
    ds_read_b64_tr_b16 v[84:85], v3 offset:17408
    ds_read_b64_tr_b16 v[86:87], v3 offset:19456
    s_waitcnt lgkmcnt(10)
    v_mfma_f32_32x32x16_bf16 v[48:63], v[64:67], v[192:195], v[48:63]
    ds_read_b64_tr_b16 v[64:65], v3 offset:20480
    ds_read_b64_tr_b16 v[66:67], v3 offset:22528
    s_waitcnt lgkmcnt(10)
    v_mfma_f32_32x32x16_bf16 v[48:63], v[68:71], v[196:199], v[48:63]
    ds_read_b64_tr_b16 v[68:69], v3 offset:21504
    ds_read_b64_tr_b16 v[70:71], v3 offset:23552
    s_waitcnt lgkmcnt(10)
    v_mfma_f32_32x32x16_bf16 v[48:63], v[72:75], v[200:203], v[48:63]
    ds_read_b64_tr_b16 v[72:73], v3 offset:24576
    ds_read_b64_tr_b16 v[74:75], v3 offset:26624
    s_waitcnt lgkmcnt(10)
    v_mfma_f32_32x32x16_bf16 v[48:63], v[76:79], v[204:207], v[48:63]
    ds_read_b64_tr_b16 v[76:77], v3 offset:25600
    ds_read_b64_tr_b16 v[78:79], v3 offset:27648
    s_waitcnt lgkmcnt(10)
    v_mfma_f32_32x32x16_bf16 v[48:63], v[80:83], v[208:211], v[48:63]
    ds_read_b64_tr_b16 v[80:81], v3 offset:28672
    ds_read_b64_tr_b16 v[82:83], v3 offset:30720
    s_waitcnt lgkmcnt(10)
    v_mfma_f32_32x32x16_bf16 v[48:63], v[84:87], v[212:215], v[48:63]
    ds_read_b64_tr_b16 v[84:85], v3 offset:29696
    ds_read_b64_tr_b16 v[86:87], v3 offset:31744
    s_waitcnt lgkmcnt(10)
    v_mfma_f32_32x32x16_bf16 v[48:63], v[64:67], v[216:219], v[48:63]
    s_waitcnt lgkmcnt(8)
    v_mfma_f32_32x32x16_bf16 v[48:63], v[68:71], v[220:223], v[48:63]
    s_waitcnt lgkmcnt(6)
    v_mfma_f32_32x32x16_bf16 v[48:63], v[72:75], v[224:227], v[48:63]
    s_waitcnt lgkmcnt(4)
    v_mfma_f32_32x32x16_bf16 v[48:63], v[76:79], v[228:231], v[48:63]
    s_waitcnt lgkmcnt(2)
    v_mfma_f32_32x32x16_bf16 v[48:63], v[80:83], v[232:235], v[48:63]
    s_waitcnt lgkmcnt(0)
    v_mfma_f32_32x32x16_bf16 v[48:63], v[84:87], v[236:239], v[48:63]
    s_nop 11
    v_cvt_pk_bf16_f32 v48, v48, v49
    v_cvt_pk_bf16_f32 v49, v50, v51
    v_cvt_pk_bf16_f32 v50, v52, v53
    v_cvt_pk_bf16_f32 v51, v54, v55
    s_nop 1
    v_permlane32_swap_b32 v48, v50
    v_permlane32_swap_b32 v49, v51
    v_bfi_b32 v48, s63, v251, v48
    v_bfi_b32 v50, s63, v253, v50
    v_bfi_b32 v49, s63, v252, v49
    v_bfi_b32 v51, s63, v254, v51
    buffer_store_dwordx4 v[48:51], v250, s[44:47], s11 offen offset:0 sc1
    v_cvt_pk_bf16_f32 v56, v56, v57
    v_cvt_pk_bf16_f32 v57, v58, v59
    v_cvt_pk_bf16_f32 v58, v60, v61
    v_cvt_pk_bf16_f32 v59, v62, v63
    s_nop 1
    v_permlane32_swap_b32 v56, v58
    v_permlane32_swap_b32 v57, v59
    v_bfi_b32 v56, s63, v251, v56
    v_bfi_b32 v58, s63, v253, v58
    v_bfi_b32 v57, s63, v252, v57
    v_bfi_b32 v59, s63, v254, v59
    buffer_store_dwordx4 v[56:59], v250, s[44:47], s11 offen offset:256 sc1
    s_barrier
    s_mov_b32 s44, s30
    s_mov_b32 s45, s31
    s_mov_b32 s46, 268435456
    s_mov_b32 s47, 0x00020000
    s_mov_b32 s58, 0
    s_mov_b32 s40, s26
    s_mov_b32 s41, s27
    s_mov_b32 s42, 589824
    s_mov_b32 s43, 0x00020000
    s_add_u32 s13, s36, 8
    v_lshlrev_b32 v64, 2, v1
    s_lshl_b32 s61, s13, 5
    s_lshl_b32 s60, s36, 8
    s_add_u32 s60, s60, 131072
    v_lshrrev_b32 v112, 5, v1
    v_and_b32 v113, 3, v1
    v_lshlrev_b32 v113, 2, v113
    v_lshl_add_u32 v112, v112, 4, v113
    v_bfe_u32 v114, v1, 2, 3
    v_and_b32 v115, 15, v1
    v_lshlrev_b32 v115, 1, v115
    s_mul_i32 s53, s35, 384
    s_add_u32 s61, s61, s53
    s_waitcnt vmcnt(6)
    v_mov_b32 v66, v249
    s_lshl_b32 s53, s32, 3
    s_lshl_b32 s55, s34, 6
    s_add_u32 s53, s53, s55
    s_mul_i32 s53, s53, 1152
    s_add_u32 s61, s61, s53
    v_mul_u32_u24 v114, 1152, v114
    v_add_u32 v65, v112, v114
    s_mul_i32 s53, s33, 196608
    s_add_u32 s60, s60, s53
    s_mul_i32 s53, s32, 8192
    s_add_u32 s60, s60, s53
    s_add_u32 s60, s60, 155713536
    v_mov_b32 v117, 0
    v_lshrrev_b32 v115, v115, s7
    v_bfe_u32 v120, v115, 0, 2
    v_mul_u32_u24 v120, 0x8001, v120
    v_mov_b32 v124, 0x10001
    v_mov_b32 v125, 0xffff0000
    v_lshlrev_b32 v72, 16, v66
    v_and_b32 v73, v125, v66
    s_waitcnt vmcnt(0)
    s_add_u32 s53, s60, 0
    buffer_load_dword v80, v64, s[44:47], s53 offen sc1
    s_add_u32 s53, s60, 1024
    buffer_load_dword v81, v64, s[44:47], s53 offen sc1
    s_add_u32 s53, s60, 2048
    buffer_load_dword v82, v64, s[44:47], s53 offen sc1
    s_add_u32 s53, s60, 3072
    buffer_load_dword v83, v64, s[44:47], s53 offen sc1
    s_add_u32 s53, s60, 4096
    buffer_load_dword v84, v64, s[44:47], s53 offen sc1
    s_add_u32 s53, s60, 5120
    buffer_load_dword v85, v64, s[44:47], s53 offen sc1
    s_add_u32 s53, s60, 6144
    buffer_load_dword v86, v64, s[44:47], s53 offen sc1
    s_add_u32 s53, s60, 7168
    buffer_load_dword v87, v64, s[44:47], s53 offen sc1
    s_waitcnt vmcnt(7)
    v_bitop3_b32 v116, v80, v120, v124 bitop3:0x28
    v_lshlrev_b32 v112, 16, v80
    v_cmp_ne_u32 s[16:17], 0, v116
    v_and_b32 v113, v125, v80
    v_pk_add_f32 v[72:73], v[72:73], v[112:113]
    s_waitcnt vmcnt(6)
    v_bitop3_b32 v116, v81, v120, v124 bitop3:0x28
    v_lshlrev_b32 v112, 16, v81
    v_cmp_ne_u32 s[18:19], 0, v116
    v_and_b32 v113, v125, v81
    v_pk_add_f32 v[72:73], v[72:73], v[112:113]
    s_waitcnt vmcnt(5)
    v_bitop3_b32 v116, v82, v120, v124 bitop3:0x28
    v_lshlrev_b32 v112, 16, v82
    v_cmp_ne_u32 s[20:21], 0, v116
    v_and_b32 v113, v125, v82
    v_pk_add_f32 v[72:73], v[72:73], v[112:113]
    s_or_b64 vcc, s[16:17], s[18:19]
    s_waitcnt vmcnt(4)
    v_bitop3_b32 v116, v83, v120, v124 bitop3:0x28
    v_lshlrev_b32 v112, 16, v83
    v_cmp_ne_u32 s[22:23], 0, v116
    v_and_b32 v113, v125, v83
    v_pk_add_f32 v[72:73], v[72:73], v[112:113]
    s_or_b64 vcc, vcc, s[20:21]
    s_waitcnt vmcnt(3)
    v_bitop3_b32 v116, v84, v120, v124 bitop3:0x28
    v_lshlrev_b32 v112, 16, v84
    v_cmp_ne_u32 s[24:25], 0, v116
    v_and_b32 v113, v125, v84
    v_pk_add_f32 v[72:73], v[72:73], v[112:113]
    s_or_b64 vcc, vcc, s[22:23]
    s_waitcnt vmcnt(2)
    v_bitop3_b32 v116, v85, v120, v124 bitop3:0x28
    v_lshlrev_b32 v112, 16, v85
    v_cmp_ne_u32 s[26:27], 0, v116
    v_and_b32 v113, v125, v85
    v_pk_add_f32 v[72:73], v[72:73], v[112:113]
    s_or_b64 vcc, vcc, s[24:25]
    s_waitcnt vmcnt(1)
    v_bitop3_b32 v116, v86, v120, v124 bitop3:0x28
    v_lshlrev_b32 v112, 16, v86
    v_cmp_ne_u32 s[28:29], 0, v116
    v_and_b32 v113, v125, v86
    v_pk_add_f32 v[72:73], v[72:73], v[112:113]
    s_or_b64 vcc, vcc, s[26:27]
    s_waitcnt vmcnt(0)
    v_bitop3_b32 v116, v87, v120, v124 bitop3:0x28
    v_lshlrev_b32 v112, 16, v87
    v_cmp_ne_u32 s[30:31], 0, v116
    v_and_b32 v113, v125, v87
    v_pk_add_f32 v[72:73], v[72:73], v[112:113]
    s_or_b64 vcc, vcc, s[28:29]
    s_or_b64 vcc, vcc, s[30:31]
    s_cbranch_scc0 L_rdone1
L_rretry1:
    s_mov_b32 s57, 0
    s_cmp_lg_u64 s[30:31], 0
    s_addc_u32 s57, s57, s57
    s_cmp_lg_u64 s[28:29], 0
    s_addc_u32 s57, s57, s57
    s_cmp_lg_u64 s[26:27], 0
    s_addc_u32 s57, s57, s57
    s_cmp_lg_u64 s[24:25], 0
    s_addc_u32 s57, s57, s57
    s_cmp_lg_u64 s[22:23], 0
    s_addc_u32 s57, s57, s57
    s_cmp_lg_u64 s[20:21], 0
    s_addc_u32 s57, s57, s57
    s_cmp_lg_u64 s[18:19], 0
    s_addc_u32 s57, s57, s57
    s_cmp_lg_u64 s[16:17], 0
    s_addc_u32 s57, s57, s57
    s_xor_b32 s56, s57, 0xff
    v_lshlrev_b32 v72, 16, v66
    v_and_b32 v73, v125, v66
L_rtop1:
    s_and_b32 s52, s57, 15
    s_cbranch_scc0 L_rl1g0
    s_bitcmp0_b32 s57, 0
    s_cbranch_scc1 L_rl1s0
    s_add_u32 s53, s60, 0
    buffer_load_dword v80, v64, s[44:47], s53 offen sc1
L_rl1s0:
    s_bitcmp0_b32 s57, 1
    s_cbranch_scc1 L_rl1s1
    s_add_u32 s53, s60, 1024
    buffer_load_dword v81, v64, s[44:47], s53 offen sc1
L_rl1s1:
    s_bitcmp0_b32 s57, 2
    s_cbranch_scc1 L_rl1s2
    s_add_u32 s53, s60, 2048
    buffer_load_dword v82, v64, s[44:47], s53 offen sc1
L_rl1s2:
    s_bitcmp0_b32 s57, 3
    s_cbranch_scc1 L_rl1s3
    s_add_u32 s53, s60, 3072
    buffer_load_dword v83, v64, s[44:47], s53 offen sc1
L_rl1s3:
L_rl1g0:
    s_and_b32 s52, s57, 240
    s_cbranch_scc0 L_rl1g1
    s_bitcmp0_b32 s57, 4
    s_cbranch_scc1 L_rl1s4
    s_add_u32 s53, s60, 4096
    buffer_load_dword v84, v64, s[44:47], s53 offen sc1
L_rl1s4:
    s_bitcmp0_b32 s57, 5
    s_cbranch_scc1 L_rl1s5
    s_add_u32 s53, s60, 5120
    buffer_load_dword v85, v64, s[44:47], s53 offen sc1
L_rl1s5:
    s_bitcmp0_b32 s57, 6
    s_cbranch_scc1 L_rl1s6
    s_add_u32 s53, s60, 6144
    buffer_load_dword v86, v64, s[44:47], s53 offen sc1
L_rl1s6:
    s_bitcmp0_b32 s57, 7
    s_cbranch_scc1 L_rl1s7
    s_add_u32 s53, s60, 7168
    buffer_load_dword v87, v64, s[44:47], s53 offen sc1
L_rl1s7:
L_rl1g1:
    s_and_b32 s52, s56, 15
    s_cbranch_scc0 L_ra1g0
    s_bitcmp0_b32 s56, 0
    s_cbranch_scc1 L_ra1s0
    v_lshlrev_b32 v112, 16, v80
    v_and_b32 v113, v125, v80
    v_pk_add_f32 v[72:73], v[72:73], v[112:113]
L_ra1s0:
    s_bitcmp0_b32 s56, 1
    s_cbranch_scc1 L_ra1s1
    v_lshlrev_b32 v112, 16, v81
    v_and_b32 v113, v125, v81
    v_pk_add_f32 v[72:73], v[72:73], v[112:113]
L_ra1s1:
    s_bitcmp0_b32 s56, 2
    s_cbranch_scc1 L_ra1s2
    v_lshlrev_b32 v112, 16, v82
    v_and_b32 v113, v125, v82
    v_pk_add_f32 v[72:73], v[72:73], v[112:113]
L_ra1s2:
    s_bitcmp0_b32 s56, 3
    s_cbranch_scc1 L_ra1s3
    v_lshlrev_b32 v112, 16, v83
    v_and_b32 v113, v125, v83
    v_pk_add_f32 v[72:73], v[72:73], v[112:113]
L_ra1s3:
L_ra1g0:
    s_and_b32 s52, s56, 240
    s_cbranch_scc0 L_ra1g1
    s_bitcmp0_b32 s56, 4
    s_cbranch_scc1 L_ra1s4
    v_lshlrev_b32 v112, 16, v84
    v_and_b32 v113, v125, v84
    v_pk_add_f32 v[72:73], v[72:73], v[112:113]
L_ra1s4:
    s_bitcmp0_b32 s56, 5
    s_cbranch_scc1 L_ra1s5
    v_lshlrev_b32 v112, 16, v85
    v_and_b32 v113, v125, v85
    v_pk_add_f32 v[72:73], v[72:73], v[112:113]
L_ra1s5:
    s_bitcmp0_b32 s56, 6
    s_cbranch_scc1 L_ra1s6
    v_lshlrev_b32 v112, 16, v86
    v_and_b32 v113, v125, v86
    v_pk_add_f32 v[72:73], v[72:73], v[112:113]
L_ra1s6:
    s_bitcmp0_b32 s56, 7
    s_cbranch_scc1 L_ra1s7
    v_lshlrev_b32 v112, 16, v87
    v_and_b32 v113, v125, v87
    v_pk_add_f32 v[72:73], v[72:73], v[112:113]
L_ra1s7:
L_ra1g1:
    s_add_u32 s58, s58, 1
    s_mov_b32 s56, s57
    s_cmp_gt_u32 s58, 100000
    s_cbranch_scc1 L_rdone1
    s_waitcnt vmcnt(0)
    s_and_b32 s52, s56, 15
    s_cbranch_scc0 L_rc1g0
    s_bitcmp0_b32 s56, 0
    s_cbranch_scc1 L_rc1s0
    v_bitop3_b32 v116, v80, v120, v124 bitop3:0x28
    v_cmp_ne_u32 vcc, 0, v116
    s_cbranch_vccnz L_rc1s0
    s_bitset0_b32 s57, 0
    v_lshlrev_b32 v112, 16, v80
    v_and_b32 v113, v125, v80
    v_pk_add_f32 v[72:73], v[72:73], v[112:113]
L_rc1s0:
    s_bitcmp0_b32 s56, 1
    s_cbranch_scc1 L_rc1s1
    v_bitop3_b32 v116, v81, v120, v124 bitop3:0x28
    v_cmp_ne_u32 vcc, 0, v116
    s_cbranch_vccnz L_rc1s1
    s_bitset0_b32 s57, 1
    v_lshlrev_b32 v112, 16, v81
    v_and_b32 v113, v125, v81
    v_pk_add_f32 v[72:73], v[72:73], v[112:113]
L_rc1s1:
    s_bitcmp0_b32 s56, 2
    s_cbranch_scc1 L_rc1s2
    v_bitop3_b32 v116, v82, v120, v124 bitop3:0x28
    v_cmp_ne_u32 vcc, 0, v116
    s_cbranch_vccnz L_rc1s2
    s_bitset0_b32 s57, 2
    v_lshlrev_b32 v112, 16, v82
    v_and_b32 v113, v125, v82
    v_pk_add_f32 v[72:73], v[72:73], v[112:113]
L_rc1s2:
    s_bitcmp0_b32 s56, 3
    s_cbranch_scc1 L_rc1s3
    v_bitop3_b32 v116, v83, v120, v124 bitop3:0x28
    v_cmp_ne_u32 vcc, 0, v116
    s_cbranch_vccnz L_rc1s3
    s_bitset0_b32 s57, 3
    v_lshlrev_b32 v112, 16, v83
    v_and_b32 v113, v125, v83
    v_pk_add_f32 v[72:73], v[72:73], v[112:113]
L_rc1s3:
L_rc1g0:
    s_and_b32 s52, s56, 240
    s_cbranch_scc0 L_rc1g1
    s_bitcmp0_b32 s56, 4
    s_cbranch_scc1 L_rc1s4
    v_bitop3_b32 v116, v84, v120, v124 bitop3:0x28
    v_cmp_ne_u32 vcc, 0, v116
    s_cbranch_vccnz L_rc1s4
    s_bitset0_b32 s57, 4
    v_lshlrev_b32 v112, 16, v84
    v_and_b32 v113, v125, v84
    v_pk_add_f32 v[72:73], v[72:73], v[112:113]
L_rc1s4:
    s_bitcmp0_b32 s56, 5
    s_cbranch_scc1 L_rc1s5
    v_bitop3_b32 v116, v85, v120, v124 bitop3:0x28
    v_cmp_ne_u32 vcc, 0, v116
    s_cbranch_vccnz L_rc1s5
    s_bitset0_b32 s57, 5
    v_lshlrev_b32 v112, 16, v85
    v_and_b32 v113, v125, v85
    v_pk_add_f32 v[72:73], v[72:73], v[112:113]
L_rc1s5:
    s_bitcmp0_b32 s56, 6
    s_cbranch_scc1 L_rc1s6
    v_bitop3_b32 v116, v86, v120, v124 bitop3:0x28
    v_cmp_ne_u32 vcc, 0, v116
    s_cbranch_vccnz L_rc1s6
    s_bitset0_b32 s57, 6
    v_lshlrev_b32 v112, 16, v86
    v_and_b32 v113, v125, v86
    v_pk_add_f32 v[72:73], v[72:73], v[112:113]
L_rc1s6:
    s_bitcmp0_b32 s56, 7
    s_cbranch_scc1 L_rc1s7
    v_bitop3_b32 v116, v87, v120, v124 bitop3:0x28
    v_cmp_ne_u32 vcc, 0, v116
    s_cbranch_vccnz L_rc1s7
    s_bitset0_b32 s57, 7
    v_lshlrev_b32 v112, 16, v87
    v_and_b32 v113, v125, v87
    v_pk_add_f32 v[72:73], v[72:73], v[112:113]
L_rc1s7:
L_rc1g1:
    s_mov_b32 s56, 0
    s_cmp_lg_u32 s57, 0
    s_cbranch_scc1 L_rtop1
L_rdone1:
    v_cvt_pk_bf16_f32 v72, v72, v73
    buffer_store_dword v72, v65, s[40:43], s61 offen
    s_branch L_end
L_tail_red:
L_reduce:
    s_mov_b32 s44, s30
    s_mov_b32 s45, s31
    s_mov_b32 s46, 268435456
    s_mov_b32 s47, 0x00020000
    s_mov_b32 s58, 0
    s_mov_b32 s40, s26
    s_mov_b32 s41, s27
    s_mov_b32 s42, 589824
    s_mov_b32 s43, 0x00020000
    s_cmp_ge_u32 s13, 2
    s_cbranch_scc1 L_rlate
    s_add_u32 s53, s60, 0
    buffer_load_dwordx2 v[80:81], v64, s[44:47], s53 offen sc1
    s_add_u32 s53, s60, 1024
    buffer_load_dwordx2 v[82:83], v64, s[44:47], s53 offen sc1
    s_add_u32 s53, s60, 2048
    buffer_load_dwordx2 v[84:85], v64, s[44:47], s53 offen sc1
    s_add_u32 s53, s60, 3072
    buffer_load_dwordx2 v[86:87], v64, s[44:47], s53 offen sc1
    s_add_u32 s53, s60, 4096
    buffer_load_dwordx2 v[88:89], v64, s[44:47], s53 offen sc1
    s_add_u32 s53, s60, 5120
    buffer_load_dwordx2 v[90:91], v64, s[44:47], s53 offen sc1
    s_add_u32 s53, s60, 6144
    buffer_load_dwordx2 v[92:93], v64, s[44:47], s53 offen sc1
    s_add_u32 s53, s60, 7168
    buffer_load_dwordx2 v[94:95], v64, s[44:47], s53 offen sc1
    s_barrier
    s_branch L_rfirst
L_rlate:
    s_barrier
    s_add_u32 s53, s60, 0
    buffer_load_dwordx2 v[80:81], v64, s[44:47], s53 offen sc1
    s_add_u32 s53, s60, 1024
    buffer_load_dwordx2 v[82:83], v64, s[44:47], s53 offen sc1
    s_add_u32 s53, s60, 2048
    buffer_load_dwordx2 v[84:85], v64, s[44:47], s53 offen sc1
    s_add_u32 s53, s60, 3072
    buffer_load_dwordx2 v[86:87], v64, s[44:47], s53 offen sc1
    s_add_u32 s53, s60, 4096
    buffer_load_dwordx2 v[88:89], v64, s[44:47], s53 offen sc1
    s_add_u32 s53, s60, 5120
    buffer_load_dwordx2 v[90:91], v64, s[44:47], s53 offen sc1
    s_add_u32 s53, s60, 6144
    buffer_load_dwordx2 v[92:93], v64, s[44:47], s53 offen sc1
    s_add_u32 s53, s60, 7168
    buffer_load_dwordx2 v[94:95], v64, s[44:47], s53 offen sc1
L_rfirst:
    s_waitcnt vmcnt(7)
    v_xor_b32 v116, v80, v120
    v_lshlrev_b32 v112, 16, v80
    v_bitop3_b32 v116, v116, v81, v121 bitop3:0xf6
    v_and_b32 v113, v125, v80
    v_and_b32 v116, v124, v116
    v_lshlrev_b32 v114, 16, v81
    v_cmp_ne_u32 s[16:17], 0, v116
    v_and_b32 v115, v125, v81
    v_pk_add_f32 v[72:73], v[72:73], v[112:113]
    v_pk_add_f32 v[74:75], v[74:75], v[114:115]
    s_waitcnt vmcnt(6)
    v_xor_b32 v116, v82, v120
    v_lshlrev_b32 v112, 16, v82
    v_bitop3_b32 v116, v116, v83, v121 bitop3:0xf6
    v_and_b32 v113, v125, v82
    v_and_b32 v116, v124, v116
    v_lshlrev_b32 v114, 16, v83
    v_cmp_ne_u32 s[18:19], 0, v116
    v_and_b32 v115, v125, v83
    v_pk_add_f32 v[72:73], v[72:73], v[112:113]
    v_pk_add_f32 v[74:75], v[74:75], v[114:115]
    s_waitcnt vmcnt(5)
    v_xor_b32 v116, v84, v120
    v_lshlrev_b32 v112, 16, v84
    v_bitop3_b32 v116, v116, v85, v121 bitop3:0xf6
    v_and_b32 v113, v125, v84
    v_and_b32 v116, v124, v116
    v_lshlrev_b32 v114, 16, v85
    v_cmp_ne_u32 s[20:21], 0, v116
    v_and_b32 v115, v125, v85
    v_pk_add_f32 v[72:73], v[72:73], v[112:113]
    v_pk_add_f32 v[74:75], v[74:75], v[114:115]
    s_or_b64 vcc, s[16:17], s[18:19]
    s_waitcnt vmcnt(4)
    v_xor_b32 v116, v86, v120
    v_lshlrev_b32 v112, 16, v86
    v_bitop3_b32 v116, v116, v87, v121 bitop3:0xf6
    v_and_b32 v113, v125, v86
    v_and_b32 v116, v124, v116
    v_lshlrev_b32 v114, 16, v87
    v_cmp_ne_u32 s[22:23], 0, v116
    v_and_b32 v115, v125, v87
    v_pk_add_f32 v[72:73], v[72:73], v[112:113]
    v_pk_add_f32 v[74:75], v[74:75], v[114:115]
    s_or_b64 vcc, vcc, s[20:21]
    s_waitcnt vmcnt(3)
    v_xor_b32 v116, v88, v120
    v_lshlrev_b32 v112, 16, v88
    v_bitop3_b32 v116, v116, v89, v121 bitop3:0xf6
    v_and_b32 v113, v125, v88
    v_and_b32 v116, v124, v116
    v_lshlrev_b32 v114, 16, v89
    v_cmp_ne_u32 s[24:25], 0, v116
    v_and_b32 v115, v125, v89
    v_pk_add_f32 v[72:73], v[72:73], v[112:113]
    v_pk_add_f32 v[74:75], v[74:75], v[114:115]
    s_or_b64 vcc, vcc, s[22:23]
    s_waitcnt vmcnt(2)
    v_xor_b32 v116, v90, v120
    v_lshlrev_b32 v112, 16, v90
    v_bitop3_b32 v116, v116, v91, v121 bitop3:0xf6
    v_and_b32 v113, v125, v90
    v_and_b32 v116, v124, v116
    v_lshlrev_b32 v114, 16, v91
    v_cmp_ne_u32 s[26:27], 0, v116
    v_and_b32 v115, v125, v91
    v_pk_add_f32 v[72:73], v[72:73], v[112:113]
    v_pk_add_f32 v[74:75], v[74:75], v[114:115]
    s_or_b64 vcc, vcc, s[24:25]
    s_waitcnt vmcnt(1)
    v_xor_b32 v116, v92, v120
    v_lshlrev_b32 v112, 16, v92
    v_bitop3_b32 v116, v116, v93, v121 bitop3:0xf6
    v_and_b32 v113, v125, v92
    v_and_b32 v116, v124, v116
    v_lshlrev_b32 v114, 16, v93
    v_cmp_ne_u32 s[28:29], 0, v116
    v_and_b32 v115, v125, v93
    v_pk_add_f32 v[72:73], v[72:73], v[112:113]
    v_pk_add_f32 v[74:75], v[74:75], v[114:115]
    s_or_b64 vcc, vcc, s[26:27]
    s_waitcnt vmcnt(0)
    v_xor_b32 v116, v94, v120
    v_lshlrev_b32 v112, 16, v94
    v_bitop3_b32 v116, v116, v95, v121 bitop3:0xf6
    v_and_b32 v113, v125, v94
    v_and_b32 v116, v124, v116
    v_lshlrev_b32 v114, 16, v95
    v_cmp_ne_u32 s[30:31], 0, v116
    v_and_b32 v115, v125, v95
    v_pk_add_f32 v[72:73], v[72:73], v[112:113]
    v_pk_add_f32 v[74:75], v[74:75], v[114:115]
    s_or_b64 vcc, vcc, s[28:29]
    s_or_b64 vcc, vcc, s[30:31]
    s_cbranch_scc0 L_rdone2
L_rretry2:
    s_mov_b32 s57, 0
    s_cmp_lg_u64 s[30:31], 0
    s_addc_u32 s57, s57, s57
    s_cmp_lg_u64 s[28:29], 0
    s_addc_u32 s57, s57, s57
    s_cmp_lg_u64 s[26:27], 0
    s_addc_u32 s57, s57, s57
    s_cmp_lg_u64 s[24:25], 0
    s_addc_u32 s57, s57, s57
    s_cmp_lg_u64 s[22:23], 0
    s_addc_u32 s57, s57, s57
    s_cmp_lg_u64 s[20:21], 0
    s_addc_u32 s57, s57, s57
    s_cmp_lg_u64 s[18:19], 0
    s_addc_u32 s57, s57, s57
    s_cmp_lg_u64 s[16:17], 0
    s_addc_u32 s57, s57, s57
    s_xor_b32 s56, s57, 0xff
    v_lshlrev_b32 v72, 16, v66
    v_and_b32 v73, v125, v66
    v_lshlrev_b32 v74, 16, v67
    v_and_b32 v75, v125, v67
L_rtop2:
    s_and_b32 s52, s57, 15
    s_cbranch_scc0 L_rl2g0
    s_bitcmp0_b32 s57, 0
    s_cbranch_scc1 L_rl2s0
    s_add_u32 s53, s60, 0
    buffer_load_dwordx2 v[80:81], v64, s[44:47], s53 offen sc1
L_rl2s0:
    s_bitcmp0_b32 s57, 1
    s_cbranch_scc1 L_rl2s1
    s_add_u32 s53, s60, 1024
    buffer_load_dwordx2 v[82:83], v64, s[44:47], s53 offen sc1
L_rl2s1:
    s_bitcmp0_b32 s57, 2
    s_cbranch_scc1 L_rl2s2
    s_add_u32 s53, s60, 2048
    buffer_load_dwordx2 v[84:85], v64, s[44:47], s53 offen sc1
L_rl2s2:
    s_bitcmp0_b32 s57, 3
    s_cbranch_scc1 L_rl2s3
    s_add_u32 s53, s60, 3072
    buffer_load_dwordx2 v[86:87], v64, s[44:47], s53 offen sc1
L_rl2s3:
L_rl2g0:
    s_and_b32 s52, s57, 240
    s_cbranch_scc0 L_rl2g1
    s_bitcmp0_b32 s57, 4
    s_cbranch_scc1 L_rl2s4
    s_add_u32 s53, s60, 4096
    buffer_load_dwordx2 v[88:89], v64, s[44:47], s53 offen sc1
L_rl2s4:
    s_bitcmp0_b32 s57, 5
    s_cbranch_scc1 L_rl2s5
    s_add_u32 s53, s60, 5120
    buffer_load_dwordx2 v[90:91], v64, s[44:47], s53 offen sc1
L_rl2s5:
    s_bitcmp0_b32 s57, 6
    s_cbranch_scc1 L_rl2s6
    s_add_u32 s53, s60, 6144
    buffer_load_dwordx2 v[92:93], v64, s[44:47], s53 offen sc1
L_rl2s6:
    s_bitcmp0_b32 s57, 7
    s_cbranch_scc1 L_rl2s7
    s_add_u32 s53, s60, 7168
    buffer_load_dwordx2 v[94:95], v64, s[44:47], s53 offen sc1
L_rl2s7:
L_rl2g1:
    s_and_b32 s52, s56, 15
    s_cbranch_scc0 L_ra2g0
    s_bitcmp0_b32 s56, 0
    s_cbranch_scc1 L_ra2s0
    v_lshlrev_b32 v112, 16, v80
    v_and_b32 v113, v125, v80
    v_lshlrev_b32 v114, 16, v81
    v_and_b32 v115, v125, v81
    v_pk_add_f32 v[72:73], v[72:73], v[112:113]
    v_pk_add_f32 v[74:75], v[74:75], v[114:115]
L_ra2s0:
    s_bitcmp0_b32 s56, 1
    s_cbranch_scc1 L_ra2s1
    v_lshlrev_b32 v112, 16, v82
    v_and_b32 v113, v125, v82
    v_lshlrev_b32 v114, 16, v83
    v_and_b32 v115, v125, v83
    v_pk_add_f32 v[72:73], v[72:73], v[112:113]
    v_pk_add_f32 v[74:75], v[74:75], v[114:115]
L_ra2s1:
    s_bitcmp0_b32 s56, 2
    s_cbranch_scc1 L_ra2s2
    v_lshlrev_b32 v112, 16, v84
    v_and_b32 v113, v125, v84
    v_lshlrev_b32 v114, 16, v85
    v_and_b32 v115, v125, v85
    v_pk_add_f32 v[72:73], v[72:73], v[112:113]
    v_pk_add_f32 v[74:75], v[74:75], v[114:115]
L_ra2s2:
    s_bitcmp0_b32 s56, 3
    s_cbranch_scc1 L_ra2s3
    v_lshlrev_b32 v112, 16, v86
    v_and_b32 v113, v125, v86
    v_lshlrev_b32 v114, 16, v87
    v_and_b32 v115, v125, v87
    v_pk_add_f32 v[72:73], v[72:73], v[112:113]
    v_pk_add_f32 v[74:75], v[74:75], v[114:115]
L_ra2s3:
L_ra2g0:
    s_and_b32 s52, s56, 240
    s_cbranch_scc0 L_ra2g1
    s_bitcmp0_b32 s56, 4
    s_cbranch_scc1 L_ra2s4
    v_lshlrev_b32 v112, 16, v88
    v_and_b32 v113, v125, v88
    v_lshlrev_b32 v114, 16, v89
    v_and_b32 v115, v125, v89
    v_pk_add_f32 v[72:73], v[72:73], v[112:113]
    v_pk_add_f32 v[74:75], v[74:75], v[114:115]
L_ra2s4:
    s_bitcmp0_b32 s56, 5
    s_cbranch_scc1 L_ra2s5
    v_lshlrev_b32 v112, 16, v90
    v_and_b32 v113, v125, v90
    v_lshlrev_b32 v114, 16, v91
    v_and_b32 v115, v125, v91
    v_pk_add_f32 v[72:73], v[72:73], v[112:113]
    v_pk_add_f32 v[74:75], v[74:75], v[114:115]
L_ra2s5:
    s_bitcmp0_b32 s56, 6
    s_cbranch_scc1 L_ra2s6
    v_lshlrev_b32 v112, 16, v92
    v_and_b32 v113, v125, v92
    v_lshlrev_b32 v114, 16, v93
    v_and_b32 v115, v125, v93
    v_pk_add_f32 v[72:73], v[72:73], v[112:113]
    v_pk_add_f32 v[74:75], v[74:75], v[114:115]
L_ra2s6:
    s_bitcmp0_b32 s56, 7
    s_cbranch_scc1 L_ra2s7
    v_lshlrev_b32 v112, 16, v94
    v_and_b32 v113, v125, v94
    v_lshlrev_b32 v114, 16, v95
    v_and_b32 v115, v125, v95
    v_pk_add_f32 v[72:73], v[72:73], v[112:113]
    v_pk_add_f32 v[74:75], v[74:75], v[114:115]
L_ra2s7:
L_ra2g1:
    s_add_u32 s58, s58, 1
    s_mov_b32 s56, s57
    s_cmp_gt_u32 s58, 100000
    s_cbranch_scc1 L_rdone2
    s_waitcnt vmcnt(0)
    s_and_b32 s52, s56, 15
    s_cbranch_scc0 L_rc2g0
    s_bitcmp0_b32 s56, 0
    s_cbranch_scc1 L_rc2s0
    v_xor_b32 v116, v80, v120
    v_bitop3_b32 v116, v116, v81, v121 bitop3:0xf6
    v_and_b32 v116, v124, v116
    v_cmp_ne_u32 vcc, 0, v116
    s_cbranch_vccnz L_rc2s0
    s_bitset0_b32 s57, 0
    v_lshlrev_b32 v112, 16, v80
    v_and_b32 v113, v125, v80
    v_lshlrev_b32 v114, 16, v81
    v_and_b32 v115, v125, v81
    v_pk_add_f32 v[72:73], v[72:73], v[112:113]
    v_pk_add_f32 v[74:75], v[74:75], v[114:115]
L_rc2s0:
    s_bitcmp0_b32 s56, 1
    s_cbranch_scc1 L_rc2s1
    v_xor_b32 v116, v82, v120
    v_bitop3_b32 v116, v116, v83, v121 bitop3:0xf6
    v_and_b32 v116, v124, v116
    v_cmp_ne_u32 vcc, 0, v116
    s_cbranch_vccnz L_rc2s1
    s_bitset0_b32 s57, 1
    v_lshlrev_b32 v112, 16, v82
    v_and_b32 v113, v125, v82
    v_lshlrev_b32 v114, 16, v83
    v_and_b32 v115, v125, v83
    v_pk_add_f32 v[72:73], v[72:73], v[112:113]
    v_pk_add_f32 v[74:75], v[74:75], v[114:115]
L_rc2s1:
    s_bitcmp0_b32 s56, 2
    s_cbranch_scc1 L_rc2s2
    v_xor_b32 v116, v84, v120
    v_bitop3_b32 v116, v116, v85, v121 bitop3:0xf6
    v_and_b32 v116, v124, v116
    v_cmp_ne_u32 vcc, 0, v116
    s_cbranch_vccnz L_rc2s2
    s_bitset0_b32 s57, 2
    v_lshlrev_b32 v112, 16, v84
    v_and_b32 v113, v125, v84
    v_lshlrev_b32 v114, 16, v85
    v_and_b32 v115, v125, v85
    v_pk_add_f32 v[72:73], v[72:73], v[112:113]
    v_pk_add_f32 v[74:75], v[74:75], v[114:115]
L_rc2s2:
    s_bitcmp0_b32 s56, 3
    s_cbranch_scc1 L_rc2s3
    v_xor_b32 v116, v86, v120
    v_bitop3_b32 v116, v116, v87, v121 bitop3:0xf6
    v_and_b32 v116, v124, v116
    v_cmp_ne_u32 vcc, 0, v116
    s_cbranch_vccnz L_rc2s3
    s_bitset0_b32 s57, 3
    v_lshlrev_b32 v112, 16, v86
    v_and_b32 v113, v125, v86
    v_lshlrev_b32 v114, 16, v87
    v_and_b32 v115, v125, v87
    v_pk_add_f32 v[72:73], v[72:73], v[112:113]
    v_pk_add_f32 v[74:75], v[74:75], v[114:115]
L_rc2s3:
L_rc2g0:
    s_and_b32 s52, s56, 240
    s_cbranch_scc0 L_rc2g1
    s_bitcmp0_b32 s56, 4
    s_cbranch_scc1 L_rc2s4
    v_xor_b32 v116, v88, v120
    v_bitop3_b32 v116, v116, v89, v121 bitop3:0xf6
    v_and_b32 v116, v124, v116
    v_cmp_ne_u32 vcc, 0, v116
    s_cbranch_vccnz L_rc2s4
    s_bitset0_b32 s57, 4
    v_lshlrev_b32 v112, 16, v88
    v_and_b32 v113, v125, v88
    v_lshlrev_b32 v114, 16, v89
    v_and_b32 v115, v125, v89
    v_pk_add_f32 v[72:73], v[72:73], v[112:113]
    v_pk_add_f32 v[74:75], v[74:75], v[114:115]
L_rc2s4:
    s_bitcmp0_b32 s56, 5
    s_cbranch_scc1 L_rc2s5
    v_xor_b32 v116, v90, v120
    v_bitop3_b32 v116, v116, v91, v121 bitop3:0xf6
    v_and_b32 v116, v124, v116
    v_cmp_ne_u32 vcc, 0, v116
    s_cbranch_vccnz L_rc2s5
    s_bitset0_b32 s57, 5
    v_lshlrev_b32 v112, 16, v90
    v_and_b32 v113, v125, v90
    v_lshlrev_b32 v114, 16, v91
    v_and_b32 v115, v125, v91
    v_pk_add_f32 v[72:73], v[72:73], v[112:113]
    v_pk_add_f32 v[74:75], v[74:75], v[114:115]
L_rc2s5:
    s_bitcmp0_b32 s56, 6
    s_cbranch_scc1 L_rc2s6
    v_xor_b32 v116, v92, v120
    v_bitop3_b32 v116, v116, v93, v121 bitop3:0xf6
    v_and_b32 v116, v124, v116
    v_cmp_ne_u32 vcc, 0, v116
    s_cbranch_vccnz L_rc2s6
    s_bitset0_b32 s57, 6
    v_lshlrev_b32 v112, 16, v92
    v_and_b32 v113, v125, v92
    v_lshlrev_b32 v114, 16, v93
    v_and_b32 v115, v125, v93
    v_pk_add_f32 v[72:73], v[72:73], v[112:113]
    v_pk_add_f32 v[74:75], v[74:75], v[114:115]
L_rc2s6:
    s_bitcmp0_b32 s56, 7
    s_cbranch_scc1 L_rc2s7
    v_xor_b32 v116, v94, v120
    v_bitop3_b32 v116, v116, v95, v121 bitop3:0xf6
    v_and_b32 v116, v124, v116
    v_cmp_ne_u32 vcc, 0, v116
    s_cbranch_vccnz L_rc2s7
    s_bitset0_b32 s57, 7
    v_lshlrev_b32 v112, 16, v94
    v_and_b32 v113, v125, v94
    v_lshlrev_b32 v114, 16, v95
    v_and_b32 v115, v125, v95
    v_pk_add_f32 v[72:73], v[72:73], v[112:113]
    v_pk_add_f32 v[74:75], v[74:75], v[114:115]
L_rc2s7:
L_rc2g1:
    s_mov_b32 s56, 0
    s_cmp_lg_u32 s57, 0
    s_cbranch_scc1 L_rtop2
L_rdone2:
    v_cvt_pk_bf16_f32 v72, v72, v73
    v_cvt_pk_bf16_f32 v73, v74, v75
    buffer_store_dwordx2 v[72:73], v65, s[40:43], s61 offen
    s_or_b32 s52, s32, s35
    s_or_b32 s52, s52, s13
    s_cmp_lg_u32 s52, 0
    s_cbranch_scc1 L_noep
    v_mov_b32 v16, s6
    s_lshl_b32 s52, s34, 7
    s_add_u32 s52, s52, 163577856
    s_mov_b64 exec, 1
    buffer_store_dword v16, v117, s[44:47], s52 offen sc1
    s_mov_b64 exec, -1
L_noep:
    s_branch L_end
L_tail_late:
L_tail_end:
L_end:
    s_endpgm
.section .rodata,"a"
.p2align 6
.amdhsa_kernel standalone__dense_activation_squared_relu__sampling_kernel
  .amdhsa_next_free_vgpr 256
  .amdhsa_next_free_sgpr 102
  .amdhsa_accum_offset 256
  .amdhsa_group_segment_fixed_size 0
  .amdhsa_kernarg_size 64
  .amdhsa_user_sgpr_count 2
  .amdhsa_user_sgpr_kernarg_segment_ptr 1
  .amdhsa_system_sgpr_workgroup_id_x 1
.end_amdhsa_kernel
```
